```python
import torch

def _softmax(x, axis=-1):
    return torch.softmax(x, dim=axis)
def _gelu(x):
    return torch.nn.functional.gelu(x, approximate="tanh")
def _silu(x):
    return torch.nn.functional.silu(x)
def _sigmoid(x):
    return torch.sigmoid(x)
def _layernorm(x, axis=-1, eps=1e-5):
    m = x.mean(dim=axis, keepdim=True)
    v = x.var(dim=axis, keepdim=True, unbiased=False)
    return (x - m) / torch.sqrt(v + eps)
def _scatter_add(tgt, idx, src, axis=0):
    return tgt.clone().index_add_(axis, idx, src)
def _segment_sum(src, seg, n):
    out = torch.zeros((n,) + src.shape[1:], dtype=src.dtype)
    return out.index_add_(0, seg, src)
def _pad(x, pw):
    flat = tuple(v for pair in reversed(pw) for v in pair)
    return torch.nn.functional.pad(x, flat)

kernel_name = 'gated_mix__mha_block__dense_activation_mish__prompt'

def setup_inputs():

    _w = (lambda a: (lambda t: t.to(torch.bfloat16) if t.is_floating_point() else t)(torch.as_tensor(a)))
    def _A_setup():
        B, S, D, H = 1, 2048, 512, 32
        return {
            "x": _w((lambda *s: torch.randn(*s, dtype=torch.bfloat16) * 0.05)(B, S, D)),
            "wqkv": _w((lambda *s: torch.randn(*s, dtype=torch.bfloat16) * 0.8)(D, 3 * D)),
            "wo": _w((lambda *s: torch.randn(*s, dtype=torch.bfloat16) * 0.05)(D, D)),
        }
    _A_in = _A_setup()

    def _B_setup():
        B, S, D, F = 1, 2048, 512, 1376
        return {
            "x": _w((lambda *s: torch.randn(*s, dtype=torch.bfloat16) * 0.05)(B, S, D)),
            "w1": _w((lambda *s: torch.randn(*s, dtype=torch.bfloat16) * 12.8)(D, F) * (D ** -0.5)),
            "b1": _w((lambda *s: torch.randn(*s, dtype=torch.bfloat16) * 0.2)(F)),
            "w2": _w((lambda *s: torch.randn(*s, dtype=torch.bfloat16) * 0.1)(F, D) * (F ** -0.5)),
        }
    _B_in = _B_setup()

    return {
        "A_x": _A_in["x"],
        "A_wqkv": _A_in["wqkv"],
        "A_wo": _A_in["wo"],
        "B_x": _B_in["x"],
        "B_w1": _B_in["w1"],
        "B_b1": _B_in["b1"],
        "B_w2": _B_in["w2"],
        "gate_w": _w((lambda *s: torch.randn(*s, dtype=torch.bfloat16) * 0.05)(512) * 16.0),
    }

def reference(A_x, A_wqkv, A_wo, B_x, B_w1, B_b1, B_w2, gate_w):
    def _A_ref(x, wqkv, wo):
        B, S, D = x.shape
        H = 32
        Dh = D // H
        qkv = (lambda x, *d: x.permute(*d))((x @ wqkv).reshape(B, S, 3, H, Dh), 2, 0, 3, 1, 4)
        q, k, v = qkv[0], qkv[1], qkv[2]
        scores = torch.einsum("bhqd,bhkd->bhqk", q, k) * (Dh ** -0.5)
        p = _softmax(scores, axis=-1)
        o = torch.einsum("bhqk,bhkd->bhqd", p, v)
        return (lambda x, *d: x.permute(*d))(o, 0, 2, 1, 3).reshape(B, S, D) @ wo

    def _B_ref(x, w1, b1, w2):
        h = torch.einsum("bsd,df->bsf", x, w1) + b1
        sp = torch.log1p(torch.exp(-torch.abs(h))) + torch.where(h > 0, h, torch.zeros_like(h))
        act = h * torch.tanh(sp)
        return torch.einsum("bsf,fd->bsd", act, w2)

    x = A_x
    g = _sigmoid((x * gate_w).sum(-1, keepdims=True))
    a = _A_ref(x, A_wqkv, A_wo)
    b = _B_ref(x, B_w1, B_b1, B_w2)
    return g * a + (1 - g) * b
```

```asm
; @launch kernel=k1_kernel grid=(256,1,1) block=(512,1,1) lds=135168
; @launch kernel=k2_kernel grid=(256,1,1) block=(640,1,1) lds=163840
.amdgcn_target "amdgcn-amd-amdhsa--gfx950"
.text
.globl k1_kernel
.p2align 8
.type k1_kernel,@function
k1_kernel:
    s_cmp_ge_u32 s2, 256
    s_cbranch_scc1 K1_END
    s_load_dwordx16 s[16:31], s[0:1], 0
    s_load_dwordx2 s[32:33], s[0:1], 80
    v_lshrrev_b32 v2, 6, v0
    v_and_b32 v1, 63, v0
    s_nop 0
    v_readfirstlane_b32 s3, v2
    s_lshr_b32 s4, s2, 3
    s_and_b32 s5, s2, 7
    s_waitcnt lgkmcnt(0)
    s_mov_b32 s36, s16
    s_and_b32 s37, s17, 0xffff
    s_mov_b32 s38, 2097152
    s_mov_b32 s39, 0x20000
    s_mov_b32 s44, s32
    s_and_b32 s45, s33, 0xffff
    s_mov_b32 s46, 41943040
    s_mov_b32 s47, 0x20000
    s_cmp_ge_u32 s2, 248
    s_cbranch_scc1 K1_GATE
    s_mov_b32 s48, s26
    s_and_b32 s49, s27, 0xffff
    s_mov_b32 s50, 2752
    s_mov_b32 s51, 0x20000
    s_mov_b32 s42, 1409024
    s_mov_b32 s6, 2752
    s_cmp_lt_u32 s4, 16
    s_cselect_b32 s40, s18, s24
    s_cselect_b32 s41, s19, s25
    s_cselect_b32 s42, 1572864, s42
    s_mov_b32 s43, 0x20000
    s_cselect_b32 s6, 3072, s6
    s_cselect_b32 s8, 0, 16
    s_and_b32 s41, s41, 0xffff
    s_sub_u32 s8, s4, s8
    s_mul_i32 s7, s8, 96
    s_mul_i32 s9, s8, 3
    v_and_b32 v2, 31, v1
    v_lshrrev_b32 v3, 5, v1
    v_lshrrev_b32 v4, 3, v1
    v_lshlrev_b32 v4, 10, v4
    v_and_b32 v5, 7, v1
    v_lshrrev_b32 v6, 4, v1
    v_xor_b32 v7, v5, v6
    v_lshl_add_u32 v10, v7, 4, v4
    v_add_u32 v6, 4, v6
    v_xor_b32 v7, v5, v6
    v_lshl_add_u32 v11, v7, 4, v4
    s_add_u32 s10, s3, 8
    s_cmp_lt_u32 s3, 4
    s_cselect_b32 s10, s10, s3
    s_lshl_b32 s11, s7, 1
    s_mov_b32 s12, 0x15555556
    s_lshl_b32 s13, s3, 6
    s_lshl_b32 s14, s10, 6
    v_add_u32 v4, s13, v1
    v_mul_hi_u32 v5, v4, s12
    v_mul_u32_u24 v6, 12, v5
    v_sub_u32 v6, v4, v6
    v_mul_lo_u32 v5, v5, s6
    v_lshl_add_u32 v5, v6, 4, v5
    v_add_u32 v12, s11, v5
    v_add_u32 v4, s14, v1
    v_mul_hi_u32 v5, v4, s12
    v_mul_u32_u24 v6, 12, v5
    v_sub_u32 v6, v4, v6
    v_mul_lo_u32 v5, v5, s6
    v_lshl_add_u32 v5, v6, 4, v5
    v_add_u32 v13, s11, v5
    s_lshl_b32 s58, s5, 18
    s_lshl_b32 s59, s3, 15
    s_add_u32 s58, s58, s59
    s_lshl_b32 s60, s3, 12
    s_lshl_b32 s61, s3, 10
    s_add_u32 s61, s61, 32768
    s_lshl_b32 s57, s10, 10
    s_add_u32 s57, s57, 32768
    s_lshl_b32 s62, s6, 6
    s_add_u32 m0, s60, 0
    s_add_u32 s63, s58, 0
    buffer_load_dwordx4 v10, s[36:39], s63 offen lds
    s_add_u32 m0, s60, 1024
    s_add_u32 s63, s58, 8192
    buffer_load_dwordx4 v11, s[36:39], s63 offen lds
    s_add_u32 m0, s60, 2048
    s_add_u32 s63, s58, 16384
    buffer_load_dwordx4 v10, s[36:39], s63 offen lds
    s_add_u32 m0, s60, 3072
    s_add_u32 s63, s58, 24576
    buffer_load_dwordx4 v11, s[36:39], s63 offen lds
    s_mul_i32 s63, s62, 0
    s_add_u32 m0, s61, 0
    s_nop 0
    buffer_load_dwordx4 v12, s[40:43], s63 offen lds
    s_mul_i32 s63, s62, 0
    s_add_u32 m0, s57, 0
    s_nop 0
    buffer_load_dwordx4 v13, s[40:43], s63 offen lds
    s_cmp_lt_u32 s4, 16
    s_cbranch_scc1 K1_NOB1
    v_lshlrev_b32 v4, 3, v3
    v_add_u32 v4, s11, v4
    buffer_load_dwordx2 v[32:33], v4, s[48:51], 0 offen offset:0
    buffer_load_dwordx2 v[34:35], v4, s[48:51], 0 offen offset:16
    buffer_load_dwordx2 v[36:37], v4, s[48:51], 0 offen offset:32
    buffer_load_dwordx2 v[38:39], v4, s[48:51], 0 offen offset:48
    buffer_load_dwordx2 v[40:41], v4, s[48:51], 0 offen offset:64
    buffer_load_dwordx2 v[42:43], v4, s[48:51], 0 offen offset:80
    buffer_load_dwordx2 v[44:45], v4, s[48:51], 0 offen offset:96
    buffer_load_dwordx2 v[46:47], v4, s[48:51], 0 offen offset:112
    buffer_load_dwordx2 v[48:49], v4, s[48:51], 0 offen offset:128
    buffer_load_dwordx2 v[50:51], v4, s[48:51], 0 offen offset:144
    buffer_load_dwordx2 v[52:53], v4, s[48:51], 0 offen offset:160
    buffer_load_dwordx2 v[54:55], v4, s[48:51], 0 offen offset:176
K1_NOB1:
    s_add_u32 m0, s60, 45056
    s_add_u32 s63, s58, 128
    buffer_load_dwordx4 v10, s[36:39], s63 offen lds
    s_add_u32 m0, s60, 46080
    s_add_u32 s63, s58, 8320
    buffer_load_dwordx4 v11, s[36:39], s63 offen lds
    s_add_u32 m0, s60, 47104
    s_add_u32 s63, s58, 16512
    buffer_load_dwordx4 v10, s[36:39], s63 offen lds
    s_add_u32 m0, s60, 48128
    s_add_u32 s63, s58, 24704
    buffer_load_dwordx4 v11, s[36:39], s63 offen lds
    s_mul_i32 s63, s62, 1
    s_add_u32 m0, s61, 45056
    s_nop 0
    buffer_load_dwordx4 v12, s[40:43], s63 offen lds
    s_mul_i32 s63, s62, 1
    s_add_u32 m0, s57, 45056
    s_nop 0
    buffer_load_dwordx4 v13, s[40:43], s63 offen lds
    v_lshrrev_b32 v4, 1, v2
    v_and_b32 v4, 7, v4
    v_lshlrev_b32 v5, 7, v2
    v_add_u32 v5, s60, v5
    v_add_u32 v6, 0, v3
    v_xor_b32 v6, v6, v4
    v_lshl_add_u32 v16, v6, 4, v5
    v_add_u32 v6, 2, v3
    v_xor_b32 v6, v6, v4
    v_lshl_add_u32 v17, v6, 4, v5
    v_add_u32 v6, 4, v3
    v_xor_b32 v6, v6, v4
    v_lshl_add_u32 v18, v6, 4, v5
    v_add_u32 v6, 6, v3
    v_xor_b32 v6, v6, v4
    v_lshl_add_u32 v19, v6, 4, v5
    v_add_u32 v20, 45056, v16
    v_add_u32 v21, 45056, v17
    v_add_u32 v22, 45056, v18
    v_add_u32 v23, 45056, v19
    v_add_u32 v24, 90112, v16
    v_add_u32 v25, 90112, v17
    v_add_u32 v26, 90112, v18
    v_add_u32 v27, 90112, v19
    v_bfe_u32 v4, v1, 2, 2
    v_lshl_add_u32 v4, v3, 3, v4
    v_mul_u32_u24 v4, 192, v4
    v_bfe_u32 v5, v1, 4, 1
    v_lshl_add_u32 v4, v5, 5, v4
    v_and_b32 v5, 3, v1
    v_lshl_add_u32 v4, v5, 3, v4
    v_add_u32 v28, 32768, v4
    v_add_u32 v29, 77824, v4
    v_add_u32 v30, 122880, v4
    s_cmp_ge_u32 s4, 16
    s_cbranch_scc1 K1_INITB
    v_mov_b32 v88, 0
    v_mov_b32 v89, 0
    v_mov_b32 v90, 0
    v_mov_b32 v91, 0
    v_mov_b32 v92, 0
    v_mov_b32 v93, 0
    v_mov_b32 v94, 0
    v_mov_b32 v95, 0
    v_mov_b32 v96, 0
    v_mov_b32 v97, 0
    v_mov_b32 v98, 0
    v_mov_b32 v99, 0
    v_mov_b32 v100, 0
    v_mov_b32 v101, 0
    v_mov_b32 v102, 0
    v_mov_b32 v103, 0
    v_mov_b32 v104, 0
    v_mov_b32 v105, 0
    v_mov_b32 v106, 0
    v_mov_b32 v107, 0
    v_mov_b32 v108, 0
    v_mov_b32 v109, 0
    v_mov_b32 v110, 0
    v_mov_b32 v111, 0
    v_mov_b32 v112, 0
    v_mov_b32 v113, 0
    v_mov_b32 v114, 0
    v_mov_b32 v115, 0
    v_mov_b32 v116, 0
    v_mov_b32 v117, 0
    v_mov_b32 v118, 0
    v_mov_b32 v119, 0
    v_mov_b32 v120, 0
    v_mov_b32 v121, 0
    v_mov_b32 v122, 0
    v_mov_b32 v123, 0
    v_mov_b32 v124, 0
    v_mov_b32 v125, 0
    v_mov_b32 v126, 0
    v_mov_b32 v127, 0
    v_mov_b32 v128, 0
    v_mov_b32 v129, 0
    v_mov_b32 v130, 0
    v_mov_b32 v131, 0
    v_mov_b32 v132, 0
    v_mov_b32 v133, 0
    v_mov_b32 v134, 0
    v_mov_b32 v135, 0
    s_branch K1_INITD
K1_INITB:
    s_waitcnt vmcnt(6)
    v_lshlrev_b32 v88, 16, v32
    v_and_b32 v89, 0xffff0000, v32
    v_lshlrev_b32 v90, 16, v33
    v_and_b32 v91, 0xffff0000, v33
    v_lshlrev_b32 v92, 16, v34
    v_and_b32 v93, 0xffff0000, v34
    v_lshlrev_b32 v94, 16, v35
    v_and_b32 v95, 0xffff0000, v35
    v_lshlrev_b32 v96, 16, v36
    v_and_b32 v97, 0xffff0000, v36
    v_lshlrev_b32 v98, 16, v37
    v_and_b32 v99, 0xffff0000, v37
    v_lshlrev_b32 v100, 16, v38
    v_and_b32 v101, 0xffff0000, v38
    v_lshlrev_b32 v102, 16, v39
    v_and_b32 v103, 0xffff0000, v39
    v_lshlrev_b32 v104, 16, v40
    v_and_b32 v105, 0xffff0000, v40
    v_lshlrev_b32 v106, 16, v41
    v_and_b32 v107, 0xffff0000, v41
    v_lshlrev_b32 v108, 16, v42
    v_and_b32 v109, 0xffff0000, v42
    v_lshlrev_b32 v110, 16, v43
    v_and_b32 v111, 0xffff0000, v43
    v_lshlrev_b32 v112, 16, v44
    v_and_b32 v113, 0xffff0000, v44
    v_lshlrev_b32 v114, 16, v45
    v_and_b32 v115, 0xffff0000, v45
    v_lshlrev_b32 v116, 16, v46
    v_and_b32 v117, 0xffff0000, v46
    v_lshlrev_b32 v118, 16, v47
    v_and_b32 v119, 0xffff0000, v47
    v_lshlrev_b32 v120, 16, v48
    v_and_b32 v121, 0xffff0000, v48
    v_lshlrev_b32 v122, 16, v49
    v_and_b32 v123, 0xffff0000, v49
    v_lshlrev_b32 v124, 16, v50
    v_and_b32 v125, 0xffff0000, v50
    v_lshlrev_b32 v126, 16, v51
    v_and_b32 v127, 0xffff0000, v51
    v_lshlrev_b32 v128, 16, v52
    v_and_b32 v129, 0xffff0000, v52
    v_lshlrev_b32 v130, 16, v53
    v_and_b32 v131, 0xffff0000, v53
    v_lshlrev_b32 v132, 16, v54
    v_and_b32 v133, 0xffff0000, v54
    v_lshlrev_b32 v134, 16, v55
    v_and_b32 v135, 0xffff0000, v55
K1_INITD:
    s_cmp_eq_u32 s4, 10
    s_cbranch_scc1 K1_TTN
    s_cmp_lt_u32 s4, 11
    s_cbranch_scc1 K1_TTT
    s_cmp_lt_u32 s4, 16
    s_cbranch_scc1 K1_NNN
K1_TTT:
    s_waitcnt vmcnt(6)
    s_barrier
    ds_read_b128 v[56:59], v16
    ds_read_b64_tr_b16 v[64:65], v28 offset:0
    ds_read_b64_tr_b16 v[66:67], v28 offset:768
    ds_read_b64_tr_b16 v[68:69], v28 offset:64
    ds_read_b64_tr_b16 v[70:71], v28 offset:832
    ds_read_b64_tr_b16 v[72:73], v28 offset:128
    ds_read_b64_tr_b16 v[74:75], v28 offset:896
    ds_read_b128 v[60:63], v17
    ds_read_b64_tr_b16 v[76:77], v28 offset:3072
    ds_read_b64_tr_b16 v[78:79], v28 offset:3840
    ds_read_b64_tr_b16 v[80:81], v28 offset:3136
    ds_read_b64_tr_b16 v[82:83], v28 offset:3904
    ds_read_b64_tr_b16 v[84:85], v28 offset:3200
    ds_read_b64_tr_b16 v[86:87], v28 offset:3968
    s_waitcnt lgkmcnt(7)
    v_mfma_f32_32x32x16_bf16 v[88:103], v[64:67], v[56:59], v[88:103]
    s_add_u32 m0, s60, 90112
    s_add_u32 s63, s58, 256
    buffer_load_dwordx4 v10, s[36:39], s63 offen lds
    v_mfma_f32_32x32x16_bf16 v[104:119], v[68:71], v[56:59], v[104:119]
    s_add_u32 m0, s60, 91136
    s_add_u32 s63, s58, 8448
    buffer_load_dwordx4 v11, s[36:39], s63 offen lds
    v_mfma_f32_32x32x16_bf16 v[120:135], v[72:75], v[56:59], v[120:135]
    ds_read_b128 v[56:59], v18
    ds_read_b64_tr_b16 v[64:65], v28 offset:6144
    ds_read_b64_tr_b16 v[66:67], v28 offset:6912
    ds_read_b64_tr_b16 v[68:69], v28 offset:6208
    ds_read_b64_tr_b16 v[70:71], v28 offset:6976
    ds_read_b64_tr_b16 v[72:73], v28 offset:6272
    ds_read_b64_tr_b16 v[74:75], v28 offset:7040
    s_waitcnt lgkmcnt(7)
    v_mfma_f32_32x32x16_bf16 v[88:103], v[76:79], v[60:63], v[88:103]
    s_add_u32 m0, s60, 92160
    s_add_u32 s63, s58, 16640
    buffer_load_dwordx4 v10, s[36:39], s63 offen lds
    v_mfma_f32_32x32x16_bf16 v[104:119], v[80:83], v[60:63], v[104:119]
    s_add_u32 m0, s60, 93184
    s_add_u32 s63, s58, 24832
    buffer_load_dwordx4 v11, s[36:39], s63 offen lds
    v_mfma_f32_32x32x16_bf16 v[120:135], v[84:87], v[60:63], v[120:135]
    ds_read_b128 v[60:63], v19
    ds_read_b64_tr_b16 v[76:77], v28 offset:9216
    ds_read_b64_tr_b16 v[78:79], v28 offset:9984
    ds_read_b64_tr_b16 v[80:81], v28 offset:9280
    ds_read_b64_tr_b16 v[82:83], v28 offset:10048
    ds_read_b64_tr_b16 v[84:85], v28 offset:9344
    ds_read_b64_tr_b16 v[86:87], v28 offset:10112
    s_waitcnt lgkmcnt(7)
    v_mfma_f32_32x32x16_bf16 v[88:103], v[64:67], v[56:59], v[88:103]
    s_mul_i32 s63, s62, 2
    s_add_u32 m0, s61, 90112
    s_nop 0
    buffer_load_dwordx4 v12, s[40:43], s63 offen lds
    v_mfma_f32_32x32x16_bf16 v[104:119], v[68:71], v[56:59], v[104:119]
    s_mul_i32 s63, s62, 2
    s_add_u32 m0, s57, 90112
    s_nop 0
    buffer_load_dwordx4 v13, s[40:43], s63 offen lds
    v_mfma_f32_32x32x16_bf16 v[120:135], v[72:75], v[56:59], v[120:135]
    s_waitcnt lgkmcnt(0)
    v_mfma_f32_32x32x16_bf16 v[88:103], v[76:79], v[60:63], v[88:103]
    v_mfma_f32_32x32x16_bf16 v[104:119], v[80:83], v[60:63], v[104:119]
    v_mfma_f32_32x32x16_bf16 v[120:135], v[84:87], v[60:63], v[120:135]
    s_waitcnt vmcnt(6)
    s_barrier
    ds_read_b128 v[56:59], v20
    ds_read_b64_tr_b16 v[64:65], v29 offset:0
    ds_read_b64_tr_b16 v[66:67], v29 offset:768
    ds_read_b64_tr_b16 v[68:69], v29 offset:64
    ds_read_b64_tr_b16 v[70:71], v29 offset:832
    ds_read_b64_tr_b16 v[72:73], v29 offset:128
    ds_read_b64_tr_b16 v[74:75], v29 offset:896
    ds_read_b128 v[60:63], v21
    ds_read_b64_tr_b16 v[76:77], v29 offset:3072
    ds_read_b64_tr_b16 v[78:79], v29 offset:3840
    ds_read_b64_tr_b16 v[80:81], v29 offset:3136
    ds_read_b64_tr_b16 v[82:83], v29 offset:3904
    ds_read_b64_tr_b16 v[84:85], v29 offset:3200
    ds_read_b64_tr_b16 v[86:87], v29 offset:3968
    s_waitcnt lgkmcnt(7)
    v_mfma_f32_32x32x16_bf16 v[88:103], v[64:67], v[56:59], v[88:103]
    s_add_u32 m0, s60, 0
    s_add_u32 s63, s58, 384
    buffer_load_dwordx4 v10, s[36:39], s63 offen lds
    v_mfma_f32_32x32x16_bf16 v[104:119], v[68:71], v[56:59], v[104:119]
    s_add_u32 m0, s60, 1024
    s_add_u32 s63, s58, 8576
    buffer_load_dwordx4 v11, s[36:39], s63 offen lds
    v_mfma_f32_32x32x16_bf16 v[120:135], v[72:75], v[56:59], v[120:135]
    ds_read_b128 v[56:59], v22
    ds_read_b64_tr_b16 v[64:65], v29 offset:6144
    ds_read_b64_tr_b16 v[66:67], v29 offset:6912
    ds_read_b64_tr_b16 v[68:69], v29 offset:6208
    ds_read_b64_tr_b16 v[70:71], v29 offset:6976
    ds_read_b64_tr_b16 v[72:73], v29 offset:6272
    ds_read_b64_tr_b16 v[74:75], v29 offset:7040
    s_waitcnt lgkmcnt(7)
    v_mfma_f32_32x32x16_bf16 v[88:103], v[76:79], v[60:63], v[88:103]
    s_add_u32 m0, s60, 2048
    s_add_u32 s63, s58, 16768
    buffer_load_dwordx4 v10, s[36:39], s63 offen lds
    v_mfma_f32_32x32x16_bf16 v[104:119], v[80:83], v[60:63], v[104:119]
    s_add_u32 m0, s60, 3072
    s_add_u32 s63, s58, 24960
    buffer_load_dwordx4 v11, s[36:39], s63 offen lds
    v_mfma_f32_32x32x16_bf16 v[120:135], v[84:87], v[60:63], v[120:135]
    ds_read_b128 v[60:63], v23
    ds_read_b64_tr_b16 v[76:77], v29 offset:9216
    ds_read_b64_tr_b16 v[78:79], v29 offset:9984
    ds_read_b64_tr_b16 v[80:81], v29 offset:9280
    ds_read_b64_tr_b16 v[82:83], v29 offset:10048
    ds_read_b64_tr_b16 v[84:85], v29 offset:9344
    ds_read_b64_tr_b16 v[86:87], v29 offset:10112
    s_waitcnt lgkmcnt(7)
    v_mfma_f32_32x32x16_bf16 v[88:103], v[64:67], v[56:59], v[88:103]
    s_mul_i32 s63, s62, 3
    s_add_u32 m0, s61, 0
    s_nop 0
    buffer_load_dwordx4 v12, s[40:43], s63 offen lds
    v_mfma_f32_32x32x16_bf16 v[104:119], v[68:71], v[56:59], v[104:119]
    s_mul_i32 s63, s62, 3
    s_add_u32 m0, s57, 0
    s_nop 0
    buffer_load_dwordx4 v13, s[40:43], s63 offen lds
    v_mfma_f32_32x32x16_bf16 v[120:135], v[72:75], v[56:59], v[120:135]
    s_waitcnt lgkmcnt(0)
    v_mfma_f32_32x32x16_bf16 v[88:103], v[76:79], v[60:63], v[88:103]
    v_mfma_f32_32x32x16_bf16 v[104:119], v[80:83], v[60:63], v[104:119]
    v_mfma_f32_32x32x16_bf16 v[120:135], v[84:87], v[60:63], v[120:135]
    s_waitcnt vmcnt(6)
    s_barrier
    ds_read_b128 v[56:59], v24
    ds_read_b64_tr_b16 v[64:65], v30 offset:0
    ds_read_b64_tr_b16 v[66:67], v30 offset:768
    ds_read_b64_tr_b16 v[68:69], v30 offset:64
    ds_read_b64_tr_b16 v[70:71], v30 offset:832
    ds_read_b64_tr_b16 v[72:73], v30 offset:128
    ds_read_b64_tr_b16 v[74:75], v30 offset:896
    ds_read_b128 v[60:63], v25
    ds_read_b64_tr_b16 v[76:77], v30 offset:3072
    ds_read_b64_tr_b16 v[78:79], v30 offset:3840
    ds_read_b64_tr_b16 v[80:81], v30 offset:3136
    ds_read_b64_tr_b16 v[82:83], v30 offset:3904
    ds_read_b64_tr_b16 v[84:85], v30 offset:3200
    ds_read_b64_tr_b16 v[86:87], v30 offset:3968
    s_waitcnt lgkmcnt(7)
    v_mfma_f32_32x32x16_bf16 v[88:103], v[64:67], v[56:59], v[88:103]
    s_add_u32 m0, s60, 45056
    s_add_u32 s63, s58, 512
    buffer_load_dwordx4 v10, s[36:39], s63 offen lds
    v_mfma_f32_32x32x16_bf16 v[104:119], v[68:71], v[56:59], v[104:119]
    s_add_u32 m0, s60, 46080
    s_add_u32 s63, s58, 8704
    buffer_load_dwordx4 v11, s[36:39], s63 offen lds
    v_mfma_f32_32x32x16_bf16 v[120:135], v[72:75], v[56:59], v[120:135]
    ds_read_b128 v[56:59], v26
    ds_read_b64_tr_b16 v[64:65], v30 offset:6144
    ds_read_b64_tr_b16 v[66:67], v30 offset:6912
    ds_read_b64_tr_b16 v[68:69], v30 offset:6208
    ds_read_b64_tr_b16 v[70:71], v30 offset:6976
    ds_read_b64_tr_b16 v[72:73], v30 offset:6272
    ds_read_b64_tr_b16 v[74:75], v30 offset:7040
    s_waitcnt lgkmcnt(7)
    v_mfma_f32_32x32x16_bf16 v[88:103], v[76:79], v[60:63], v[88:103]
    s_add_u32 m0, s60, 47104
    s_add_u32 s63, s58, 16896
    buffer_load_dwordx4 v10, s[36:39], s63 offen lds
    v_mfma_f32_32x32x16_bf16 v[104:119], v[80:83], v[60:63], v[104:119]
    s_add_u32 m0, s60, 48128
    s_add_u32 s63, s58, 25088
    buffer_load_dwordx4 v11, s[36:39], s63 offen lds
    v_mfma_f32_32x32x16_bf16 v[120:135], v[84:87], v[60:63], v[120:135]
    ds_read_b128 v[60:63], v27
    ds_read_b64_tr_b16 v[76:77], v30 offset:9216
    ds_read_b64_tr_b16 v[78:79], v30 offset:9984
    ds_read_b64_tr_b16 v[80:81], v30 offset:9280
    ds_read_b64_tr_b16 v[82:83], v30 offset:10048
    ds_read_b64_tr_b16 v[84:85], v30 offset:9344
    ds_read_b64_tr_b16 v[86:87], v30 offset:10112
    s_waitcnt lgkmcnt(7)
    v_mfma_f32_32x32x16_bf16 v[88:103], v[64:67], v[56:59], v[88:103]
    s_mul_i32 s63, s62, 4
    s_add_u32 m0, s61, 45056
    s_nop 0
    buffer_load_dwordx4 v12, s[40:43], s63 offen lds
    v_mfma_f32_32x32x16_bf16 v[104:119], v[68:71], v[56:59], v[104:119]
    s_mul_i32 s63, s62, 4
    s_add_u32 m0, s57, 45056
    s_nop 0
    buffer_load_dwordx4 v13, s[40:43], s63 offen lds
    v_mfma_f32_32x32x16_bf16 v[120:135], v[72:75], v[56:59], v[120:135]
    s_waitcnt lgkmcnt(0)
    v_mfma_f32_32x32x16_bf16 v[88:103], v[76:79], v[60:63], v[88:103]
    v_mfma_f32_32x32x16_bf16 v[104:119], v[80:83], v[60:63], v[104:119]
    v_mfma_f32_32x32x16_bf16 v[120:135], v[84:87], v[60:63], v[120:135]
    s_waitcnt vmcnt(6)
    s_barrier
    ds_read_b128 v[56:59], v16
    ds_read_b64_tr_b16 v[64:65], v28 offset:0
    ds_read_b64_tr_b16 v[66:67], v28 offset:768
    ds_read_b64_tr_b16 v[68:69], v28 offset:64
    ds_read_b64_tr_b16 v[70:71], v28 offset:832
    ds_read_b64_tr_b16 v[72:73], v28 offset:128
    ds_read_b64_tr_b16 v[74:75], v28 offset:896
    ds_read_b128 v[60:63], v17
    ds_read_b64_tr_b16 v[76:77], v28 offset:3072
    ds_read_b64_tr_b16 v[78:79], v28 offset:3840
    ds_read_b64_tr_b16 v[80:81], v28 offset:3136
    ds_read_b64_tr_b16 v[82:83], v28 offset:3904
    ds_read_b64_tr_b16 v[84:85], v28 offset:3200
    ds_read_b64_tr_b16 v[86:87], v28 offset:3968
    s_waitcnt lgkmcnt(7)
    v_mfma_f32_32x32x16_bf16 v[88:103], v[64:67], v[56:59], v[88:103]
    s_add_u32 m0, s60, 90112
    s_add_u32 s63, s58, 640
    buffer_load_dwordx4 v10, s[36:39], s63 offen lds
    v_mfma_f32_32x32x16_bf16 v[104:119], v[68:71], v[56:59], v[104:119]
    s_add_u32 m0, s60, 91136
    s_add_u32 s63, s58, 8832
    buffer_load_dwordx4 v11, s[36:39], s63 offen lds
    v_mfma_f32_32x32x16_bf16 v[120:135], v[72:75], v[56:59], v[120:135]
    ds_read_b128 v[56:59], v18
    ds_read_b64_tr_b16 v[64:65], v28 offset:6144
    ds_read_b64_tr_b16 v[66:67], v28 offset:6912
    ds_read_b64_tr_b16 v[68:69], v28 offset:6208
    ds_read_b64_tr_b16 v[70:71], v28 offset:6976
    ds_read_b64_tr_b16 v[72:73], v28 offset:6272
    ds_read_b64_tr_b16 v[74:75], v28 offset:7040
    s_waitcnt lgkmcnt(7)
    v_mfma_f32_32x32x16_bf16 v[88:103], v[76:79], v[60:63], v[88:103]
    s_add_u32 m0, s60, 92160
    s_add_u32 s63, s58, 17024
    buffer_load_dwordx4 v10, s[36:39], s63 offen lds
    v_mfma_f32_32x32x16_bf16 v[104:119], v[80:83], v[60:63], v[104:119]
    s_add_u32 m0, s60, 93184
    s_add_u32 s63, s58, 25216
    buffer_load_dwordx4 v11, s[36:39], s63 offen lds
    v_mfma_f32_32x32x16_bf16 v[120:135], v[84:87], v[60:63], v[120:135]
    ds_read_b128 v[60:63], v19
    ds_read_b64_tr_b16 v[76:77], v28 offset:9216
    ds_read_b64_tr_b16 v[78:79], v28 offset:9984
    ds_read_b64_tr_b16 v[80:81], v28 offset:9280
    ds_read_b64_tr_b16 v[82:83], v28 offset:10048
    ds_read_b64_tr_b16 v[84:85], v28 offset:9344
    ds_read_b64_tr_b16 v[86:87], v28 offset:10112
    s_waitcnt lgkmcnt(7)
    v_mfma_f32_32x32x16_bf16 v[88:103], v[64:67], v[56:59], v[88:103]
    s_mul_i32 s63, s62, 5
    s_add_u32 m0, s61, 90112
    s_nop 0
    buffer_load_dwordx4 v12, s[40:43], s63 offen lds
    v_mfma_f32_32x32x16_bf16 v[104:119], v[68:71], v[56:59], v[104:119]
    s_mul_i32 s63, s62, 5
    s_add_u32 m0, s57, 90112
    s_nop 0
    buffer_load_dwordx4 v13, s[40:43], s63 offen lds
    v_mfma_f32_32x32x16_bf16 v[120:135], v[72:75], v[56:59], v[120:135]
    s_waitcnt lgkmcnt(0)
    v_mfma_f32_32x32x16_bf16 v[88:103], v[76:79], v[60:63], v[88:103]
    v_mfma_f32_32x32x16_bf16 v[104:119], v[80:83], v[60:63], v[104:119]
    v_mfma_f32_32x32x16_bf16 v[120:135], v[84:87], v[60:63], v[120:135]
    s_waitcnt vmcnt(6)
    s_barrier
    ds_read_b128 v[56:59], v20
    ds_read_b64_tr_b16 v[64:65], v29 offset:0
    ds_read_b64_tr_b16 v[66:67], v29 offset:768
    ds_read_b64_tr_b16 v[68:69], v29 offset:64
    ds_read_b64_tr_b16 v[70:71], v29 offset:832
    ds_read_b64_tr_b16 v[72:73], v29 offset:128
    ds_read_b64_tr_b16 v[74:75], v29 offset:896
    ds_read_b128 v[60:63], v21
    ds_read_b64_tr_b16 v[76:77], v29 offset:3072
    ds_read_b64_tr_b16 v[78:79], v29 offset:3840
    ds_read_b64_tr_b16 v[80:81], v29 offset:3136
    ds_read_b64_tr_b16 v[82:83], v29 offset:3904
    ds_read_b64_tr_b16 v[84:85], v29 offset:3200
    ds_read_b64_tr_b16 v[86:87], v29 offset:3968
    s_waitcnt lgkmcnt(7)
    v_mfma_f32_32x32x16_bf16 v[88:103], v[64:67], v[56:59], v[88:103]
    s_add_u32 m0, s60, 0
    s_add_u32 s63, s58, 768
    buffer_load_dwordx4 v10, s[36:39], s63 offen lds
    v_mfma_f32_32x32x16_bf16 v[104:119], v[68:71], v[56:59], v[104:119]
    s_add_u32 m0, s60, 1024
    s_add_u32 s63, s58, 8960
    buffer_load_dwordx4 v11, s[36:39], s63 offen lds
    v_mfma_f32_32x32x16_bf16 v[120:135], v[72:75], v[56:59], v[120:135]
    ds_read_b128 v[56:59], v22
    ds_read_b64_tr_b16 v[64:65], v29 offset:6144
    ds_read_b64_tr_b16 v[66:67], v29 offset:6912
    ds_read_b64_tr_b16 v[68:69], v29 offset:6208
    ds_read_b64_tr_b16 v[70:71], v29 offset:6976
    ds_read_b64_tr_b16 v[72:73], v29 offset:6272
    ds_read_b64_tr_b16 v[74:75], v29 offset:7040
    s_waitcnt lgkmcnt(7)
    v_mfma_f32_32x32x16_bf16 v[88:103], v[76:79], v[60:63], v[88:103]
    s_add_u32 m0, s60, 2048
    s_add_u32 s63, s58, 17152
    buffer_load_dwordx4 v10, s[36:39], s63 offen lds
    v_mfma_f32_32x32x16_bf16 v[104:119], v[80:83], v[60:63], v[104:119]
    s_add_u32 m0, s60, 3072
    s_add_u32 s63, s58, 25344
    buffer_load_dwordx4 v11, s[36:39], s63 offen lds
    v_mfma_f32_32x32x16_bf16 v[120:135], v[84:87], v[60:63], v[120:135]
    ds_read_b128 v[60:63], v23
    ds_read_b64_tr_b16 v[76:77], v29 offset:9216
    ds_read_b64_tr_b16 v[78:79], v29 offset:9984
    ds_read_b64_tr_b16 v[80:81], v29 offset:9280
    ds_read_b64_tr_b16 v[82:83], v29 offset:10048
    ds_read_b64_tr_b16 v[84:85], v29 offset:9344
    ds_read_b64_tr_b16 v[86:87], v29 offset:10112
    s_waitcnt lgkmcnt(7)
    v_mfma_f32_32x32x16_bf16 v[88:103], v[64:67], v[56:59], v[88:103]
    s_mul_i32 s63, s62, 6
    s_add_u32 m0, s61, 0
    s_nop 0
    buffer_load_dwordx4 v12, s[40:43], s63 offen lds
    v_mfma_f32_32x32x16_bf16 v[104:119], v[68:71], v[56:59], v[104:119]
    s_mul_i32 s63, s62, 6
    s_add_u32 m0, s57, 0
    s_nop 0
    buffer_load_dwordx4 v13, s[40:43], s63 offen lds
    v_mfma_f32_32x32x16_bf16 v[120:135], v[72:75], v[56:59], v[120:135]
    s_waitcnt lgkmcnt(0)
    v_mfma_f32_32x32x16_bf16 v[88:103], v[76:79], v[60:63], v[88:103]
    v_mfma_f32_32x32x16_bf16 v[104:119], v[80:83], v[60:63], v[104:119]
    v_mfma_f32_32x32x16_bf16 v[120:135], v[84:87], v[60:63], v[120:135]
    s_waitcnt vmcnt(6)
    s_barrier
    ds_read_b128 v[56:59], v24
    ds_read_b64_tr_b16 v[64:65], v30 offset:0
    ds_read_b64_tr_b16 v[66:67], v30 offset:768
    ds_read_b64_tr_b16 v[68:69], v30 offset:64
    ds_read_b64_tr_b16 v[70:71], v30 offset:832
    ds_read_b64_tr_b16 v[72:73], v30 offset:128
    ds_read_b64_tr_b16 v[74:75], v30 offset:896
    ds_read_b128 v[60:63], v25
    ds_read_b64_tr_b16 v[76:77], v30 offset:3072
    ds_read_b64_tr_b16 v[78:79], v30 offset:3840
    ds_read_b64_tr_b16 v[80:81], v30 offset:3136
    ds_read_b64_tr_b16 v[82:83], v30 offset:3904
    ds_read_b64_tr_b16 v[84:85], v30 offset:3200
    ds_read_b64_tr_b16 v[86:87], v30 offset:3968
    s_waitcnt lgkmcnt(7)
    v_mfma_f32_32x32x16_bf16 v[88:103], v[64:67], v[56:59], v[88:103]
    s_add_u32 m0, s60, 45056
    s_add_u32 s63, s58, 896
    buffer_load_dwordx4 v10, s[36:39], s63 offen lds
    v_mfma_f32_32x32x16_bf16 v[104:119], v[68:71], v[56:59], v[104:119]
    s_add_u32 m0, s60, 46080
    s_add_u32 s63, s58, 9088
    buffer_load_dwordx4 v11, s[36:39], s63 offen lds
    v_mfma_f32_32x32x16_bf16 v[120:135], v[72:75], v[56:59], v[120:135]
    ds_read_b128 v[56:59], v26
    ds_read_b64_tr_b16 v[64:65], v30 offset:6144
    ds_read_b64_tr_b16 v[66:67], v30 offset:6912
    ds_read_b64_tr_b16 v[68:69], v30 offset:6208
    ds_read_b64_tr_b16 v[70:71], v30 offset:6976
    ds_read_b64_tr_b16 v[72:73], v30 offset:6272
    ds_read_b64_tr_b16 v[74:75], v30 offset:7040
    s_waitcnt lgkmcnt(7)
    v_mfma_f32_32x32x16_bf16 v[88:103], v[76:79], v[60:63], v[88:103]
    s_add_u32 m0, s60, 47104
    s_add_u32 s63, s58, 17280
    buffer_load_dwordx4 v10, s[36:39], s63 offen lds
    v_mfma_f32_32x32x16_bf16 v[104:119], v[80:83], v[60:63], v[104:119]
    s_add_u32 m0, s60, 48128
    s_add_u32 s63, s58, 25472
    buffer_load_dwordx4 v11, s[36:39], s63 offen lds
    v_mfma_f32_32x32x16_bf16 v[120:135], v[84:87], v[60:63], v[120:135]
    ds_read_b128 v[60:63], v27
    ds_read_b64_tr_b16 v[76:77], v30 offset:9216
    ds_read_b64_tr_b16 v[78:79], v30 offset:9984
    ds_read_b64_tr_b16 v[80:81], v30 offset:9280
    ds_read_b64_tr_b16 v[82:83], v30 offset:10048
    ds_read_b64_tr_b16 v[84:85], v30 offset:9344
    ds_read_b64_tr_b16 v[86:87], v30 offset:10112
    s_waitcnt lgkmcnt(7)
    v_mfma_f32_32x32x16_bf16 v[88:103], v[64:67], v[56:59], v[88:103]
    s_mul_i32 s63, s62, 7
    s_add_u32 m0, s61, 45056
    s_nop 0
    buffer_load_dwordx4 v12, s[40:43], s63 offen lds
    v_mfma_f32_32x32x16_bf16 v[104:119], v[68:71], v[56:59], v[104:119]
    s_mul_i32 s63, s62, 7
    s_add_u32 m0, s57, 45056
    s_nop 0
    buffer_load_dwordx4 v13, s[40:43], s63 offen lds
    v_mfma_f32_32x32x16_bf16 v[120:135], v[72:75], v[56:59], v[120:135]
    s_waitcnt lgkmcnt(0)
    v_mfma_f32_32x32x16_bf16 v[88:103], v[76:79], v[60:63], v[88:103]
    v_mfma_f32_32x32x16_bf16 v[104:119], v[80:83], v[60:63], v[104:119]
    v_mfma_f32_32x32x16_bf16 v[120:135], v[84:87], v[60:63], v[120:135]
    s_waitcnt vmcnt(6)
    s_barrier
    ds_read_b128 v[56:59], v16
    ds_read_b64_tr_b16 v[64:65], v28 offset:0
    ds_read_b64_tr_b16 v[66:67], v28 offset:768
    ds_read_b64_tr_b16 v[68:69], v28 offset:64
    ds_read_b64_tr_b16 v[70:71], v28 offset:832
    ds_read_b64_tr_b16 v[72:73], v28 offset:128
    ds_read_b64_tr_b16 v[74:75], v28 offset:896
    ds_read_b128 v[60:63], v17
    ds_read_b64_tr_b16 v[76:77], v28 offset:3072
    ds_read_b64_tr_b16 v[78:79], v28 offset:3840
    ds_read_b64_tr_b16 v[80:81], v28 offset:3136
    ds_read_b64_tr_b16 v[82:83], v28 offset:3904
    ds_read_b64_tr_b16 v[84:85], v28 offset:3200
    ds_read_b64_tr_b16 v[86:87], v28 offset:3968
    s_waitcnt lgkmcnt(7)
    v_mfma_f32_32x32x16_bf16 v[88:103], v[64:67], v[56:59], v[88:103]
    v_mfma_f32_32x32x16_bf16 v[104:119], v[68:71], v[56:59], v[104:119]
    v_mfma_f32_32x32x16_bf16 v[120:135], v[72:75], v[56:59], v[120:135]
    ds_read_b128 v[56:59], v18
    ds_read_b64_tr_b16 v[64:65], v28 offset:6144
    ds_read_b64_tr_b16 v[66:67], v28 offset:6912
    ds_read_b64_tr_b16 v[68:69], v28 offset:6208
    ds_read_b64_tr_b16 v[70:71], v28 offset:6976
    ds_read_b64_tr_b16 v[72:73], v28 offset:6272
    ds_read_b64_tr_b16 v[74:75], v28 offset:7040
    s_waitcnt lgkmcnt(7)
    v_mfma_f32_32x32x16_bf16 v[88:103], v[76:79], v[60:63], v[88:103]
    v_mfma_f32_32x32x16_bf16 v[104:119], v[80:83], v[60:63], v[104:119]
    v_mfma_f32_32x32x16_bf16 v[120:135], v[84:87], v[60:63], v[120:135]
    ds_read_b128 v[60:63], v19
    ds_read_b64_tr_b16 v[76:77], v28 offset:9216
    ds_read_b64_tr_b16 v[78:79], v28 offset:9984
    ds_read_b64_tr_b16 v[80:81], v28 offset:9280
    ds_read_b64_tr_b16 v[82:83], v28 offset:10048
    ds_read_b64_tr_b16 v[84:85], v28 offset:9344
    ds_read_b64_tr_b16 v[86:87], v28 offset:10112
    s_waitcnt lgkmcnt(7)
    v_mfma_f32_32x32x16_bf16 v[88:103], v[64:67], v[56:59], v[88:103]
    v_mfma_f32_32x32x16_bf16 v[104:119], v[68:71], v[56:59], v[104:119]
    v_mfma_f32_32x32x16_bf16 v[120:135], v[72:75], v[56:59], v[120:135]
    s_waitcnt lgkmcnt(0)
    v_mfma_f32_32x32x16_bf16 v[88:103], v[76:79], v[60:63], v[88:103]
    v_mfma_f32_32x32x16_bf16 v[104:119], v[80:83], v[60:63], v[104:119]
    v_mfma_f32_32x32x16_bf16 v[120:135], v[84:87], v[60:63], v[120:135]
    s_waitcnt vmcnt(0)
    s_barrier
    ds_read_b128 v[56:59], v20
    ds_read_b64_tr_b16 v[64:65], v29 offset:0
    ds_read_b64_tr_b16 v[66:67], v29 offset:768
    ds_read_b64_tr_b16 v[68:69], v29 offset:64
    ds_read_b64_tr_b16 v[70:71], v29 offset:832
    ds_read_b64_tr_b16 v[72:73], v29 offset:128
    ds_read_b64_tr_b16 v[74:75], v29 offset:896
    ds_read_b128 v[60:63], v21
    ds_read_b64_tr_b16 v[76:77], v29 offset:3072
    ds_read_b64_tr_b16 v[78:79], v29 offset:3840
    ds_read_b64_tr_b16 v[80:81], v29 offset:3136
    ds_read_b64_tr_b16 v[82:83], v29 offset:3904
    ds_read_b64_tr_b16 v[84:85], v29 offset:3200
    ds_read_b64_tr_b16 v[86:87], v29 offset:3968
    s_waitcnt lgkmcnt(7)
    v_mfma_f32_32x32x16_bf16 v[88:103], v[64:67], v[56:59], v[88:103]
    v_mfma_f32_32x32x16_bf16 v[104:119], v[68:71], v[56:59], v[104:119]
    v_mfma_f32_32x32x16_bf16 v[120:135], v[72:75], v[56:59], v[120:135]
    ds_read_b128 v[56:59], v22
    ds_read_b64_tr_b16 v[64:65], v29 offset:6144
    ds_read_b64_tr_b16 v[66:67], v29 offset:6912
    ds_read_b64_tr_b16 v[68:69], v29 offset:6208
    ds_read_b64_tr_b16 v[70:71], v29 offset:6976
    ds_read_b64_tr_b16 v[72:73], v29 offset:6272
    ds_read_b64_tr_b16 v[74:75], v29 offset:7040
    s_waitcnt lgkmcnt(7)
    v_mfma_f32_32x32x16_bf16 v[88:103], v[76:79], v[60:63], v[88:103]
    v_mfma_f32_32x32x16_bf16 v[104:119], v[80:83], v[60:63], v[104:119]
    v_mfma_f32_32x32x16_bf16 v[120:135], v[84:87], v[60:63], v[120:135]
    ds_read_b128 v[60:63], v23
    ds_read_b64_tr_b16 v[76:77], v29 offset:9216
    ds_read_b64_tr_b16 v[78:79], v29 offset:9984
    ds_read_b64_tr_b16 v[80:81], v29 offset:9280
    ds_read_b64_tr_b16 v[82:83], v29 offset:10048
    ds_read_b64_tr_b16 v[84:85], v29 offset:9344
    ds_read_b64_tr_b16 v[86:87], v29 offset:10112
    s_waitcnt lgkmcnt(7)
    v_mfma_f32_32x32x16_bf16 v[88:103], v[64:67], v[56:59], v[88:103]
    v_mfma_f32_32x32x16_bf16 v[104:119], v[68:71], v[56:59], v[104:119]
    v_mfma_f32_32x32x16_bf16 v[120:135], v[72:75], v[56:59], v[120:135]
    s_waitcnt lgkmcnt(0)
    v_mfma_f32_32x32x16_bf16 v[88:103], v[76:79], v[60:63], v[88:103]
    v_mfma_f32_32x32x16_bf16 v[104:119], v[80:83], v[60:63], v[104:119]
    v_mfma_f32_32x32x16_bf16 v[120:135], v[84:87], v[60:63], v[120:135]
    s_nop 15
    s_nop 3
    s_branch K1_EPI
K1_TTN:
    s_waitcnt vmcnt(6)
    s_barrier
    ds_read_b128 v[56:59], v16
    ds_read_b64_tr_b16 v[64:65], v28 offset:0
    ds_read_b64_tr_b16 v[66:67], v28 offset:768
    ds_read_b64_tr_b16 v[68:69], v28 offset:64
    ds_read_b64_tr_b16 v[70:71], v28 offset:832
    ds_read_b64_tr_b16 v[72:73], v28 offset:128
    ds_read_b64_tr_b16 v[74:75], v28 offset:896
    ds_read_b128 v[60:63], v17
    ds_read_b64_tr_b16 v[76:77], v28 offset:3072
    ds_read_b64_tr_b16 v[78:79], v28 offset:3840
    ds_read_b64_tr_b16 v[80:81], v28 offset:3136
    ds_read_b64_tr_b16 v[82:83], v28 offset:3904
    ds_read_b64_tr_b16 v[84:85], v28 offset:3200
    ds_read_b64_tr_b16 v[86:87], v28 offset:3968
    s_waitcnt lgkmcnt(7)
    v_mfma_f32_32x32x16_bf16 v[88:103], v[64:67], v[56:59], v[88:103]
    s_add_u32 m0, s60, 90112
    s_add_u32 s63, s58, 256
    buffer_load_dwordx4 v10, s[36:39], s63 offen lds
    v_mfma_f32_32x32x16_bf16 v[104:119], v[68:71], v[56:59], v[104:119]
    s_add_u32 m0, s60, 91136
    s_add_u32 s63, s58, 8448
    buffer_load_dwordx4 v11, s[36:39], s63 offen lds
    v_mfma_f32_32x32x16_bf16 v[120:135], v[56:59], v[72:75], v[120:135]
    ds_read_b128 v[56:59], v18
    ds_read_b64_tr_b16 v[64:65], v28 offset:6144
    ds_read_b64_tr_b16 v[66:67], v28 offset:6912
    ds_read_b64_tr_b16 v[68:69], v28 offset:6208
    ds_read_b64_tr_b16 v[70:71], v28 offset:6976
    ds_read_b64_tr_b16 v[72:73], v28 offset:6272
    ds_read_b64_tr_b16 v[74:75], v28 offset:7040
    s_waitcnt lgkmcnt(7)
    v_mfma_f32_32x32x16_bf16 v[88:103], v[76:79], v[60:63], v[88:103]
    s_add_u32 m0, s60, 92160
    s_add_u32 s63, s58, 16640
    buffer_load_dwordx4 v10, s[36:39], s63 offen lds
    v_mfma_f32_32x32x16_bf16 v[104:119], v[80:83], v[60:63], v[104:119]
    s_add_u32 m0, s60, 93184
    s_add_u32 s63, s58, 24832
    buffer_load_dwordx4 v11, s[36:39], s63 offen lds
    v_mfma_f32_32x32x16_bf16 v[120:135], v[60:63], v[84:87], v[120:135]
    ds_read_b128 v[60:63], v19
    ds_read_b64_tr_b16 v[76:77], v28 offset:9216
    ds_read_b64_tr_b16 v[78:79], v28 offset:9984
    ds_read_b64_tr_b16 v[80:81], v28 offset:9280
    ds_read_b64_tr_b16 v[82:83], v28 offset:10048
    ds_read_b64_tr_b16 v[84:85], v28 offset:9344
    ds_read_b64_tr_b16 v[86:87], v28 offset:10112
    s_waitcnt lgkmcnt(7)
    v_mfma_f32_32x32x16_bf16 v[88:103], v[64:67], v[56:59], v[88:103]
    s_mul_i32 s63, s62, 2
    s_add_u32 m0, s61, 90112
    s_nop 0
    buffer_load_dwordx4 v12, s[40:43], s63 offen lds
    v_mfma_f32_32x32x16_bf16 v[104:119], v[68:71], v[56:59], v[104:119]
    s_mul_i32 s63, s62, 2
    s_add_u32 m0, s57, 90112
    s_nop 0
    buffer_load_dwordx4 v13, s[40:43], s63 offen lds
    v_mfma_f32_32x32x16_bf16 v[120:135], v[56:59], v[72:75], v[120:135]
    s_waitcnt lgkmcnt(0)
    v_mfma_f32_32x32x16_bf16 v[88:103], v[76:79], v[60:63], v[88:103]
    v_mfma_f32_32x32x16_bf16 v[104:119], v[80:83], v[60:63], v[104:119]
    v_mfma_f32_32x32x16_bf16 v[120:135], v[60:63], v[84:87], v[120:135]
    s_waitcnt vmcnt(6)
    s_barrier
    ds_read_b128 v[56:59], v20
    ds_read_b64_tr_b16 v[64:65], v29 offset:0
    ds_read_b64_tr_b16 v[66:67], v29 offset:768
    ds_read_b64_tr_b16 v[68:69], v29 offset:64
    ds_read_b64_tr_b16 v[70:71], v29 offset:832
    ds_read_b64_tr_b16 v[72:73], v29 offset:128
    ds_read_b64_tr_b16 v[74:75], v29 offset:896
    ds_read_b128 v[60:63], v21
    ds_read_b64_tr_b16 v[76:77], v29 offset:3072
    ds_read_b64_tr_b16 v[78:79], v29 offset:3840
    ds_read_b64_tr_b16 v[80:81], v29 offset:3136
    ds_read_b64_tr_b16 v[82:83], v29 offset:3904
    ds_read_b64_tr_b16 v[84:85], v29 offset:3200
    ds_read_b64_tr_b16 v[86:87], v29 offset:3968
    s_waitcnt lgkmcnt(7)
    v_mfma_f32_32x32x16_bf16 v[88:103], v[64:67], v[56:59], v[88:103]
    s_add_u32 m0, s60, 0
    s_add_u32 s63, s58, 384
    buffer_load_dwordx4 v10, s[36:39], s63 offen lds
    v_mfma_f32_32x32x16_bf16 v[104:119], v[68:71], v[56:59], v[104:119]
    s_add_u32 m0, s60, 1024
    s_add_u32 s63, s58, 8576
    buffer_load_dwordx4 v11, s[36:39], s63 offen lds
    v_mfma_f32_32x32x16_bf16 v[120:135], v[56:59], v[72:75], v[120:135]
    ds_read_b128 v[56:59], v22
    ds_read_b64_tr_b16 v[64:65], v29 offset:6144
    ds_read_b64_tr_b16 v[66:67], v29 offset:6912
    ds_read_b64_tr_b16 v[68:69], v29 offset:6208
    ds_read_b64_tr_b16 v[70:71], v29 offset:6976
    ds_read_b64_tr_b16 v[72:73], v29 offset:6272
    ds_read_b64_tr_b16 v[74:75], v29 offset:7040
    s_waitcnt lgkmcnt(7)
    v_mfma_f32_32x32x16_bf16 v[88:103], v[76:79], v[60:63], v[88:103]
    s_add_u32 m0, s60, 2048
    s_add_u32 s63, s58, 16768
    buffer_load_dwordx4 v10, s[36:39], s63 offen lds
    v_mfma_f32_32x32x16_bf16 v[104:119], v[80:83], v[60:63], v[104:119]
    s_add_u32 m0, s60, 3072
    s_add_u32 s63, s58, 24960
    buffer_load_dwordx4 v11, s[36:39], s63 offen lds
    v_mfma_f32_32x32x16_bf16 v[120:135], v[60:63], v[84:87], v[120:135]
    ds_read_b128 v[60:63], v23
    ds_read_b64_tr_b16 v[76:77], v29 offset:9216
    ds_read_b64_tr_b16 v[78:79], v29 offset:9984
    ds_read_b64_tr_b16 v[80:81], v29 offset:9280
    ds_read_b64_tr_b16 v[82:83], v29 offset:10048
    ds_read_b64_tr_b16 v[84:85], v29 offset:9344
    ds_read_b64_tr_b16 v[86:87], v29 offset:10112
    s_waitcnt lgkmcnt(7)
    v_mfma_f32_32x32x16_bf16 v[88:103], v[64:67], v[56:59], v[88:103]
    s_mul_i32 s63, s62, 3
    s_add_u32 m0, s61, 0
    s_nop 0
    buffer_load_dwordx4 v12, s[40:43], s63 offen lds
    v_mfma_f32_32x32x16_bf16 v[104:119], v[68:71], v[56:59], v[104:119]
    s_mul_i32 s63, s62, 3
    s_add_u32 m0, s57, 0
    s_nop 0
    buffer_load_dwordx4 v13, s[40:43], s63 offen lds
    v_mfma_f32_32x32x16_bf16 v[120:135], v[56:59], v[72:75], v[120:135]
    s_waitcnt lgkmcnt(0)
    v_mfma_f32_32x32x16_bf16 v[88:103], v[76:79], v[60:63], v[88:103]
    v_mfma_f32_32x32x16_bf16 v[104:119], v[80:83], v[60:63], v[104:119]
    v_mfma_f32_32x32x16_bf16 v[120:135], v[60:63], v[84:87], v[120:135]
    s_waitcnt vmcnt(6)
    s_barrier
    ds_read_b128 v[56:59], v24
    ds_read_b64_tr_b16 v[64:65], v30 offset:0
    ds_read_b64_tr_b16 v[66:67], v30 offset:768
    ds_read_b64_tr_b16 v[68:69], v30 offset:64
    ds_read_b64_tr_b16 v[70:71], v30 offset:832
    ds_read_b64_tr_b16 v[72:73], v30 offset:128
    ds_read_b64_tr_b16 v[74:75], v30 offset:896
    ds_read_b128 v[60:63], v25
    ds_read_b64_tr_b16 v[76:77], v30 offset:3072
    ds_read_b64_tr_b16 v[78:79], v30 offset:3840
    ds_read_b64_tr_b16 v[80:81], v30 offset:3136
    ds_read_b64_tr_b16 v[82:83], v30 offset:3904
    ds_read_b64_tr_b16 v[84:85], v30 offset:3200
    ds_read_b64_tr_b16 v[86:87], v30 offset:3968
    s_waitcnt lgkmcnt(7)
    v_mfma_f32_32x32x16_bf16 v[88:103], v[64:67], v[56:59], v[88:103]
    s_add_u32 m0, s60, 45056
    s_add_u32 s63, s58, 512
    buffer_load_dwordx4 v10, s[36:39], s63 offen lds
    v_mfma_f32_32x32x16_bf16 v[104:119], v[68:71], v[56:59], v[104:119]
    s_add_u32 m0, s60, 46080
    s_add_u32 s63, s58, 8704
    buffer_load_dwordx4 v11, s[36:39], s63 offen lds
    v_mfma_f32_32x32x16_bf16 v[120:135], v[56:59], v[72:75], v[120:135]
    ds_read_b128 v[56:59], v26
    ds_read_b64_tr_b16 v[64:65], v30 offset:6144
    ds_read_b64_tr_b16 v[66:67], v30 offset:6912
    ds_read_b64_tr_b16 v[68:69], v30 offset:6208
    ds_read_b64_tr_b16 v[70:71], v30 offset:6976
    ds_read_b64_tr_b16 v[72:73], v30 offset:6272
    ds_read_b64_tr_b16 v[74:75], v30 offset:7040
    s_waitcnt lgkmcnt(7)
    v_mfma_f32_32x32x16_bf16 v[88:103], v[76:79], v[60:63], v[88:103]
    s_add_u32 m0, s60, 47104
    s_add_u32 s63, s58, 16896
    buffer_load_dwordx4 v10, s[36:39], s63 offen lds
    v_mfma_f32_32x32x16_bf16 v[104:119], v[80:83], v[60:63], v[104:119]
    s_add_u32 m0, s60, 48128
    s_add_u32 s63, s58, 25088
    buffer_load_dwordx4 v11, s[36:39], s63 offen lds
    v_mfma_f32_32x32x16_bf16 v[120:135], v[60:63], v[84:87], v[120:135]
    ds_read_b128 v[60:63], v27
    ds_read_b64_tr_b16 v[76:77], v30 offset:9216
    ds_read_b64_tr_b16 v[78:79], v30 offset:9984
    ds_read_b64_tr_b16 v[80:81], v30 offset:9280
    ds_read_b64_tr_b16 v[82:83], v30 offset:10048
    ds_read_b64_tr_b16 v[84:85], v30 offset:9344
    ds_read_b64_tr_b16 v[86:87], v30 offset:10112
    s_waitcnt lgkmcnt(7)
    v_mfma_f32_32x32x16_bf16 v[88:103], v[64:67], v[56:59], v[88:103]
    s_mul_i32 s63, s62, 4
    s_add_u32 m0, s61, 45056
    s_nop 0
    buffer_load_dwordx4 v12, s[40:43], s63 offen lds
    v_mfma_f32_32x32x16_bf16 v[104:119], v[68:71], v[56:59], v[104:119]
    s_mul_i32 s63, s62, 4
    s_add_u32 m0, s57, 45056
    s_nop 0
    buffer_load_dwordx4 v13, s[40:43], s63 offen lds
    v_mfma_f32_32x32x16_bf16 v[120:135], v[56:59], v[72:75], v[120:135]
    s_waitcnt lgkmcnt(0)
    v_mfma_f32_32x32x16_bf16 v[88:103], v[76:79], v[60:63], v[88:103]
    v_mfma_f32_32x32x16_bf16 v[104:119], v[80:83], v[60:63], v[104:119]
    v_mfma_f32_32x32x16_bf16 v[120:135], v[60:63], v[84:87], v[120:135]
    s_waitcnt vmcnt(6)
    s_barrier
    ds_read_b128 v[56:59], v16
    ds_read_b64_tr_b16 v[64:65], v28 offset:0
    ds_read_b64_tr_b16 v[66:67], v28 offset:768
    ds_read_b64_tr_b16 v[68:69], v28 offset:64
    ds_read_b64_tr_b16 v[70:71], v28 offset:832
    ds_read_b64_tr_b16 v[72:73], v28 offset:128
    ds_read_b64_tr_b16 v[74:75], v28 offset:896
    ds_read_b128 v[60:63], v17
    ds_read_b64_tr_b16 v[76:77], v28 offset:3072
    ds_read_b64_tr_b16 v[78:79], v28 offset:3840
    ds_read_b64_tr_b16 v[80:81], v28 offset:3136
    ds_read_b64_tr_b16 v[82:83], v28 offset:3904
    ds_read_b64_tr_b16 v[84:85], v28 offset:3200
    ds_read_b64_tr_b16 v[86:87], v28 offset:3968
    s_waitcnt lgkmcnt(7)
    v_mfma_f32_32x32x16_bf16 v[88:103], v[64:67], v[56:59], v[88:103]
    s_add_u32 m0, s60, 90112
    s_add_u32 s63, s58, 640
    buffer_load_dwordx4 v10, s[36:39], s63 offen lds
    v_mfma_f32_32x32x16_bf16 v[104:119], v[68:71], v[56:59], v[104:119]
    s_add_u32 m0, s60, 91136
    s_add_u32 s63, s58, 8832
    buffer_load_dwordx4 v11, s[36:39], s63 offen lds
    v_mfma_f32_32x32x16_bf16 v[120:135], v[56:59], v[72:75], v[120:135]
    ds_read_b128 v[56:59], v18
    ds_read_b64_tr_b16 v[64:65], v28 offset:6144
    ds_read_b64_tr_b16 v[66:67], v28 offset:6912
    ds_read_b64_tr_b16 v[68:69], v28 offset:6208
    ds_read_b64_tr_b16 v[70:71], v28 offset:6976
    ds_read_b64_tr_b16 v[72:73], v28 offset:6272
    ds_read_b64_tr_b16 v[74:75], v28 offset:7040
    s_waitcnt lgkmcnt(7)
    v_mfma_f32_32x32x16_bf16 v[88:103], v[76:79], v[60:63], v[88:103]
    s_add_u32 m0, s60, 92160
    s_add_u32 s63, s58, 17024
    buffer_load_dwordx4 v10, s[36:39], s63 offen lds
    v_mfma_f32_32x32x16_bf16 v[104:119], v[80:83], v[60:63], v[104:119]
    s_add_u32 m0, s60, 93184
    s_add_u32 s63, s58, 25216
    buffer_load_dwordx4 v11, s[36:39], s63 offen lds
    v_mfma_f32_32x32x16_bf16 v[120:135], v[60:63], v[84:87], v[120:135]
    ds_read_b128 v[60:63], v19
    ds_read_b64_tr_b16 v[76:77], v28 offset:9216
    ds_read_b64_tr_b16 v[78:79], v28 offset:9984
    ds_read_b64_tr_b16 v[80:81], v28 offset:9280
    ds_read_b64_tr_b16 v[82:83], v28 offset:10048
    ds_read_b64_tr_b16 v[84:85], v28 offset:9344
    ds_read_b64_tr_b16 v[86:87], v28 offset:10112
    s_waitcnt lgkmcnt(7)
    v_mfma_f32_32x32x16_bf16 v[88:103], v[64:67], v[56:59], v[88:103]
    s_mul_i32 s63, s62, 5
    s_add_u32 m0, s61, 90112
    s_nop 0
    buffer_load_dwordx4 v12, s[40:43], s63 offen lds
    v_mfma_f32_32x32x16_bf16 v[104:119], v[68:71], v[56:59], v[104:119]
    s_mul_i32 s63, s62, 5
    s_add_u32 m0, s57, 90112
    s_nop 0
    buffer_load_dwordx4 v13, s[40:43], s63 offen lds
    v_mfma_f32_32x32x16_bf16 v[120:135], v[56:59], v[72:75], v[120:135]
    s_waitcnt lgkmcnt(0)
    v_mfma_f32_32x32x16_bf16 v[88:103], v[76:79], v[60:63], v[88:103]
    v_mfma_f32_32x32x16_bf16 v[104:119], v[80:83], v[60:63], v[104:119]
    v_mfma_f32_32x32x16_bf16 v[120:135], v[60:63], v[84:87], v[120:135]
    s_waitcnt vmcnt(6)
    s_barrier
    ds_read_b128 v[56:59], v20
    ds_read_b64_tr_b16 v[64:65], v29 offset:0
    ds_read_b64_tr_b16 v[66:67], v29 offset:768
    ds_read_b64_tr_b16 v[68:69], v29 offset:64
    ds_read_b64_tr_b16 v[70:71], v29 offset:832
    ds_read_b64_tr_b16 v[72:73], v29 offset:128
    ds_read_b64_tr_b16 v[74:75], v29 offset:896
    ds_read_b128 v[60:63], v21
    ds_read_b64_tr_b16 v[76:77], v29 offset:3072
    ds_read_b64_tr_b16 v[78:79], v29 offset:3840
    ds_read_b64_tr_b16 v[80:81], v29 offset:3136
    ds_read_b64_tr_b16 v[82:83], v29 offset:3904
    ds_read_b64_tr_b16 v[84:85], v29 offset:3200
    ds_read_b64_tr_b16 v[86:87], v29 offset:3968
    s_waitcnt lgkmcnt(7)
    v_mfma_f32_32x32x16_bf16 v[88:103], v[64:67], v[56:59], v[88:103]
    s_add_u32 m0, s60, 0
    s_add_u32 s63, s58, 768
    buffer_load_dwordx4 v10, s[36:39], s63 offen lds
    v_mfma_f32_32x32x16_bf16 v[104:119], v[68:71], v[56:59], v[104:119]
    s_add_u32 m0, s60, 1024
    s_add_u32 s63, s58, 8960
    buffer_load_dwordx4 v11, s[36:39], s63 offen lds
    v_mfma_f32_32x32x16_bf16 v[120:135], v[56:59], v[72:75], v[120:135]
    ds_read_b128 v[56:59], v22
    ds_read_b64_tr_b16 v[64:65], v29 offset:6144
    ds_read_b64_tr_b16 v[66:67], v29 offset:6912
    ds_read_b64_tr_b16 v[68:69], v29 offset:6208
    ds_read_b64_tr_b16 v[70:71], v29 offset:6976
    ds_read_b64_tr_b16 v[72:73], v29 offset:6272
    ds_read_b64_tr_b16 v[74:75], v29 offset:7040
    s_waitcnt lgkmcnt(7)
    v_mfma_f32_32x32x16_bf16 v[88:103], v[76:79], v[60:63], v[88:103]
    s_add_u32 m0, s60, 2048
    s_add_u32 s63, s58, 17152
    buffer_load_dwordx4 v10, s[36:39], s63 offen lds
    v_mfma_f32_32x32x16_bf16 v[104:119], v[80:83], v[60:63], v[104:119]
    s_add_u32 m0, s60, 3072
    s_add_u32 s63, s58, 25344
    buffer_load_dwordx4 v11, s[36:39], s63 offen lds
    v_mfma_f32_32x32x16_bf16 v[120:135], v[60:63], v[84:87], v[120:135]
    ds_read_b128 v[60:63], v23
    ds_read_b64_tr_b16 v[76:77], v29 offset:9216
    ds_read_b64_tr_b16 v[78:79], v29 offset:9984
    ds_read_b64_tr_b16 v[80:81], v29 offset:9280
    ds_read_b64_tr_b16 v[82:83], v29 offset:10048
    ds_read_b64_tr_b16 v[84:85], v29 offset:9344
    ds_read_b64_tr_b16 v[86:87], v29 offset:10112
    s_waitcnt lgkmcnt(7)
    v_mfma_f32_32x32x16_bf16 v[88:103], v[64:67], v[56:59], v[88:103]
    s_mul_i32 s63, s62, 6
    s_add_u32 m0, s61, 0
    s_nop 0
    buffer_load_dwordx4 v12, s[40:43], s63 offen lds
    v_mfma_f32_32x32x16_bf16 v[104:119], v[68:71], v[56:59], v[104:119]
    s_mul_i32 s63, s62, 6
    s_add_u32 m0, s57, 0
    s_nop 0
    buffer_load_dwordx4 v13, s[40:43], s63 offen lds
    v_mfma_f32_32x32x16_bf16 v[120:135], v[56:59], v[72:75], v[120:135]
    s_waitcnt lgkmcnt(0)
    v_mfma_f32_32x32x16_bf16 v[88:103], v[76:79], v[60:63], v[88:103]
    v_mfma_f32_32x32x16_bf16 v[104:119], v[80:83], v[60:63], v[104:119]
    v_mfma_f32_32x32x16_bf16 v[120:135], v[60:63], v[84:87], v[120:135]
    s_waitcnt vmcnt(6)
    s_barrier
    ds_read_b128 v[56:59], v24
    ds_read_b64_tr_b16 v[64:65], v30 offset:0
    ds_read_b64_tr_b16 v[66:67], v30 offset:768
    ds_read_b64_tr_b16 v[68:69], v30 offset:64
    ds_read_b64_tr_b16 v[70:71], v30 offset:832
    ds_read_b64_tr_b16 v[72:73], v30 offset:128
    ds_read_b64_tr_b16 v[74:75], v30 offset:896
    ds_read_b128 v[60:63], v25
    ds_read_b64_tr_b16 v[76:77], v30 offset:3072
    ds_read_b64_tr_b16 v[78:79], v30 offset:3840
    ds_read_b64_tr_b16 v[80:81], v30 offset:3136
    ds_read_b64_tr_b16 v[82:83], v30 offset:3904
    ds_read_b64_tr_b16 v[84:85], v30 offset:3200
    ds_read_b64_tr_b16 v[86:87], v30 offset:3968
    s_waitcnt lgkmcnt(7)
    v_mfma_f32_32x32x16_bf16 v[88:103], v[64:67], v[56:59], v[88:103]
    s_add_u32 m0, s60, 45056
    s_add_u32 s63, s58, 896
    buffer_load_dwordx4 v10, s[36:39], s63 offen lds
    v_mfma_f32_32x32x16_bf16 v[104:119], v[68:71], v[56:59], v[104:119]
    s_add_u32 m0, s60, 46080
    s_add_u32 s63, s58, 9088
    buffer_load_dwordx4 v11, s[36:39], s63 offen lds
    v_mfma_f32_32x32x16_bf16 v[120:135], v[56:59], v[72:75], v[120:135]
    ds_read_b128 v[56:59], v26
    ds_read_b64_tr_b16 v[64:65], v30 offset:6144
    ds_read_b64_tr_b16 v[66:67], v30 offset:6912
    ds_read_b64_tr_b16 v[68:69], v30 offset:6208
    ds_read_b64_tr_b16 v[70:71], v30 offset:6976
    ds_read_b64_tr_b16 v[72:73], v30 offset:6272
    ds_read_b64_tr_b16 v[74:75], v30 offset:7040
    s_waitcnt lgkmcnt(7)
    v_mfma_f32_32x32x16_bf16 v[88:103], v[76:79], v[60:63], v[88:103]
    s_add_u32 m0, s60, 47104
    s_add_u32 s63, s58, 17280
    buffer_load_dwordx4 v10, s[36:39], s63 offen lds
    v_mfma_f32_32x32x16_bf16 v[104:119], v[80:83], v[60:63], v[104:119]
    s_add_u32 m0, s60, 48128
    s_add_u32 s63, s58, 25472
    buffer_load_dwordx4 v11, s[36:39], s63 offen lds
    v_mfma_f32_32x32x16_bf16 v[120:135], v[60:63], v[84:87], v[120:135]
    ds_read_b128 v[60:63], v27
    ds_read_b64_tr_b16 v[76:77], v30 offset:9216
    ds_read_b64_tr_b16 v[78:79], v30 offset:9984
    ds_read_b64_tr_b16 v[80:81], v30 offset:9280
    ds_read_b64_tr_b16 v[82:83], v30 offset:10048
    ds_read_b64_tr_b16 v[84:85], v30 offset:9344
    ds_read_b64_tr_b16 v[86:87], v30 offset:10112
    s_waitcnt lgkmcnt(7)
    v_mfma_f32_32x32x16_bf16 v[88:103], v[64:67], v[56:59], v[88:103]
    s_mul_i32 s63, s62, 7
    s_add_u32 m0, s61, 45056
    s_nop 0
    buffer_load_dwordx4 v12, s[40:43], s63 offen lds
    v_mfma_f32_32x32x16_bf16 v[104:119], v[68:71], v[56:59], v[104:119]
    s_mul_i32 s63, s62, 7
    s_add_u32 m0, s57, 45056
    s_nop 0
    buffer_load_dwordx4 v13, s[40:43], s63 offen lds
    v_mfma_f32_32x32x16_bf16 v[120:135], v[56:59], v[72:75], v[120:135]
    s_waitcnt lgkmcnt(0)
    v_mfma_f32_32x32x16_bf16 v[88:103], v[76:79], v[60:63], v[88:103]
    v_mfma_f32_32x32x16_bf16 v[104:119], v[80:83], v[60:63], v[104:119]
    v_mfma_f32_32x32x16_bf16 v[120:135], v[60:63], v[84:87], v[120:135]
    s_waitcnt vmcnt(6)
    s_barrier
    ds_read_b128 v[56:59], v16
    ds_read_b64_tr_b16 v[64:65], v28 offset:0
    ds_read_b64_tr_b16 v[66:67], v28 offset:768
    ds_read_b64_tr_b16 v[68:69], v28 offset:64
    ds_read_b64_tr_b16 v[70:71], v28 offset:832
    ds_read_b64_tr_b16 v[72:73], v28 offset:128
    ds_read_b64_tr_b16 v[74:75], v28 offset:896
    ds_read_b128 v[60:63], v17
    ds_read_b64_tr_b16 v[76:77], v28 offset:3072
    ds_read_b64_tr_b16 v[78:79], v28 offset:3840
    ds_read_b64_tr_b16 v[80:81], v28 offset:3136
    ds_read_b64_tr_b16 v[82:83], v28 offset:3904
    ds_read_b64_tr_b16 v[84:85], v28 offset:3200
    ds_read_b64_tr_b16 v[86:87], v28 offset:3968
    s_waitcnt lgkmcnt(7)
    v_mfma_f32_32x32x16_bf16 v[88:103], v[64:67], v[56:59], v[88:103]
    v_mfma_f32_32x32x16_bf16 v[104:119], v[68:71], v[56:59], v[104:119]
    v_mfma_f32_32x32x16_bf16 v[120:135], v[56:59], v[72:75], v[120:135]
    ds_read_b128 v[56:59], v18
    ds_read_b64_tr_b16 v[64:65], v28 offset:6144
    ds_read_b64_tr_b16 v[66:67], v28 offset:6912
    ds_read_b64_tr_b16 v[68:69], v28 offset:6208
    ds_read_b64_tr_b16 v[70:71], v28 offset:6976
    ds_read_b64_tr_b16 v[72:73], v28 offset:6272
    ds_read_b64_tr_b16 v[74:75], v28 offset:7040
    s_waitcnt lgkmcnt(7)
    v_mfma_f32_32x32x16_bf16 v[88:103], v[76:79], v[60:63], v[88:103]
    v_mfma_f32_32x32x16_bf16 v[104:119], v[80:83], v[60:63], v[104:119]
    v_mfma_f32_32x32x16_bf16 v[120:135], v[60:63], v[84:87], v[120:135]
    ds_read_b128 v[60:63], v19
    ds_read_b64_tr_b16 v[76:77], v28 offset:9216
    ds_read_b64_tr_b16 v[78:79], v28 offset:9984
    ds_read_b64_tr_b16 v[80:81], v28 offset:9280
    ds_read_b64_tr_b16 v[82:83], v28 offset:10048
    ds_read_b64_tr_b16 v[84:85], v28 offset:9344
    ds_read_b64_tr_b16 v[86:87], v28 offset:10112
    s_waitcnt lgkmcnt(7)
    v_mfma_f32_32x32x16_bf16 v[88:103], v[64:67], v[56:59], v[88:103]
    v_mfma_f32_32x32x16_bf16 v[104:119], v[68:71], v[56:59], v[104:119]
    v_mfma_f32_32x32x16_bf16 v[120:135], v[56:59], v[72:75], v[120:135]
    s_waitcnt lgkmcnt(0)
    v_mfma_f32_32x32x16_bf16 v[88:103], v[76:79], v[60:63], v[88:103]
    v_mfma_f32_32x32x16_bf16 v[104:119], v[80:83], v[60:63], v[104:119]
    v_mfma_f32_32x32x16_bf16 v[120:135], v[60:63], v[84:87], v[120:135]
    s_waitcnt vmcnt(0)
    s_barrier
    ds_read_b128 v[56:59], v20
    ds_read_b64_tr_b16 v[64:65], v29 offset:0
    ds_read_b64_tr_b16 v[66:67], v29 offset:768
    ds_read_b64_tr_b16 v[68:69], v29 offset:64
    ds_read_b64_tr_b16 v[70:71], v29 offset:832
    ds_read_b64_tr_b16 v[72:73], v29 offset:128
    ds_read_b64_tr_b16 v[74:75], v29 offset:896
    ds_read_b128 v[60:63], v21
    ds_read_b64_tr_b16 v[76:77], v29 offset:3072
    ds_read_b64_tr_b16 v[78:79], v29 offset:3840
    ds_read_b64_tr_b16 v[80:81], v29 offset:3136
    ds_read_b64_tr_b16 v[82:83], v29 offset:3904
    ds_read_b64_tr_b16 v[84:85], v29 offset:3200
    ds_read_b64_tr_b16 v[86:87], v29 offset:3968
    s_waitcnt lgkmcnt(7)
    v_mfma_f32_32x32x16_bf16 v[88:103], v[64:67], v[56:59], v[88:103]
    v_mfma_f32_32x32x16_bf16 v[104:119], v[68:71], v[56:59], v[104:119]
    v_mfma_f32_32x32x16_bf16 v[120:135], v[56:59], v[72:75], v[120:135]
    ds_read_b128 v[56:59], v22
    ds_read_b64_tr_b16 v[64:65], v29 offset:6144
    ds_read_b64_tr_b16 v[66:67], v29 offset:6912
    ds_read_b64_tr_b16 v[68:69], v29 offset:6208
    ds_read_b64_tr_b16 v[70:71], v29 offset:6976
    ds_read_b64_tr_b16 v[72:73], v29 offset:6272
    ds_read_b64_tr_b16 v[74:75], v29 offset:7040
    s_waitcnt lgkmcnt(7)
    v_mfma_f32_32x32x16_bf16 v[88:103], v[76:79], v[60:63], v[88:103]
    v_mfma_f32_32x32x16_bf16 v[104:119], v[80:83], v[60:63], v[104:119]
    v_mfma_f32_32x32x16_bf16 v[120:135], v[60:63], v[84:87], v[120:135]
    ds_read_b128 v[60:63], v23
    ds_read_b64_tr_b16 v[76:77], v29 offset:9216
    ds_read_b64_tr_b16 v[78:79], v29 offset:9984
    ds_read_b64_tr_b16 v[80:81], v29 offset:9280
    ds_read_b64_tr_b16 v[82:83], v29 offset:10048
    ds_read_b64_tr_b16 v[84:85], v29 offset:9344
    ds_read_b64_tr_b16 v[86:87], v29 offset:10112
    s_waitcnt lgkmcnt(7)
    v_mfma_f32_32x32x16_bf16 v[88:103], v[64:67], v[56:59], v[88:103]
    v_mfma_f32_32x32x16_bf16 v[104:119], v[68:71], v[56:59], v[104:119]
    v_mfma_f32_32x32x16_bf16 v[120:135], v[56:59], v[72:75], v[120:135]
    s_waitcnt lgkmcnt(0)
    v_mfma_f32_32x32x16_bf16 v[88:103], v[76:79], v[60:63], v[88:103]
    v_mfma_f32_32x32x16_bf16 v[104:119], v[80:83], v[60:63], v[104:119]
    v_mfma_f32_32x32x16_bf16 v[120:135], v[60:63], v[84:87], v[120:135]
    s_nop 15
    s_nop 3
    s_branch K1_EPI
K1_NNN:
    s_waitcnt vmcnt(6)
    s_barrier
    ds_read_b128 v[56:59], v16
    ds_read_b64_tr_b16 v[64:65], v28 offset:0
    ds_read_b64_tr_b16 v[66:67], v28 offset:768
    ds_read_b64_tr_b16 v[68:69], v28 offset:64
    ds_read_b64_tr_b16 v[70:71], v28 offset:832
    ds_read_b64_tr_b16 v[72:73], v28 offset:128
    ds_read_b64_tr_b16 v[74:75], v28 offset:896
    ds_read_b128 v[60:63], v17
    ds_read_b64_tr_b16 v[76:77], v28 offset:3072
    ds_read_b64_tr_b16 v[78:79], v28 offset:3840
    ds_read_b64_tr_b16 v[80:81], v28 offset:3136
    ds_read_b64_tr_b16 v[82:83], v28 offset:3904
    ds_read_b64_tr_b16 v[84:85], v28 offset:3200
    ds_read_b64_tr_b16 v[86:87], v28 offset:3968
    s_waitcnt lgkmcnt(7)
    v_mfma_f32_32x32x16_bf16 v[88:103], v[56:59], v[64:67], v[88:103]
    s_add_u32 m0, s60, 90112
    s_add_u32 s63, s58, 256
    buffer_load_dwordx4 v10, s[36:39], s63 offen lds
    v_mfma_f32_32x32x16_bf16 v[104:119], v[56:59], v[68:71], v[104:119]
    s_add_u32 m0, s60, 91136
    s_add_u32 s63, s58, 8448
    buffer_load_dwordx4 v11, s[36:39], s63 offen lds
    v_mfma_f32_32x32x16_bf16 v[120:135], v[56:59], v[72:75], v[120:135]
    ds_read_b128 v[56:59], v18
    ds_read_b64_tr_b16 v[64:65], v28 offset:6144
    ds_read_b64_tr_b16 v[66:67], v28 offset:6912
    ds_read_b64_tr_b16 v[68:69], v28 offset:6208
    ds_read_b64_tr_b16 v[70:71], v28 offset:6976
    ds_read_b64_tr_b16 v[72:73], v28 offset:6272
    ds_read_b64_tr_b16 v[74:75], v28 offset:7040
    s_waitcnt lgkmcnt(7)
    v_mfma_f32_32x32x16_bf16 v[88:103], v[60:63], v[76:79], v[88:103]
    s_add_u32 m0, s60, 92160
    s_add_u32 s63, s58, 16640
    buffer_load_dwordx4 v10, s[36:39], s63 offen lds
    v_mfma_f32_32x32x16_bf16 v[104:119], v[60:63], v[80:83], v[104:119]
    s_add_u32 m0, s60, 93184
    s_add_u32 s63, s58, 24832
    buffer_load_dwordx4 v11, s[36:39], s63 offen lds
    v_mfma_f32_32x32x16_bf16 v[120:135], v[60:63], v[84:87], v[120:135]
    ds_read_b128 v[60:63], v19
    ds_read_b64_tr_b16 v[76:77], v28 offset:9216
    ds_read_b64_tr_b16 v[78:79], v28 offset:9984
    ds_read_b64_tr_b16 v[80:81], v28 offset:9280
    ds_read_b64_tr_b16 v[82:83], v28 offset:10048
    ds_read_b64_tr_b16 v[84:85], v28 offset:9344
    ds_read_b64_tr_b16 v[86:87], v28 offset:10112
    s_waitcnt lgkmcnt(7)
    v_mfma_f32_32x32x16_bf16 v[88:103], v[56:59], v[64:67], v[88:103]
    s_mul_i32 s63, s62, 2
    s_add_u32 m0, s61, 90112
    s_nop 0
    buffer_load_dwordx4 v12, s[40:43], s63 offen lds
    v_mfma_f32_32x32x16_bf16 v[104:119], v[56:59], v[68:71], v[104:119]
    s_mul_i32 s63, s62, 2
    s_add_u32 m0, s57, 90112
    s_nop 0
    buffer_load_dwordx4 v13, s[40:43], s63 offen lds
    v_mfma_f32_32x32x16_bf16 v[120:135], v[56:59], v[72:75], v[120:135]
    s_waitcnt lgkmcnt(0)
    v_mfma_f32_32x32x16_bf16 v[88:103], v[60:63], v[76:79], v[88:103]
    v_mfma_f32_32x32x16_bf16 v[104:119], v[60:63], v[80:83], v[104:119]
    v_mfma_f32_32x32x16_bf16 v[120:135], v[60:63], v[84:87], v[120:135]
    s_waitcnt vmcnt(6)
    s_barrier
    ds_read_b128 v[56:59], v20
    ds_read_b64_tr_b16 v[64:65], v29 offset:0
    ds_read_b64_tr_b16 v[66:67], v29 offset:768
    ds_read_b64_tr_b16 v[68:69], v29 offset:64
    ds_read_b64_tr_b16 v[70:71], v29 offset:832
    ds_read_b64_tr_b16 v[72:73], v29 offset:128
    ds_read_b64_tr_b16 v[74:75], v29 offset:896
    ds_read_b128 v[60:63], v21
    ds_read_b64_tr_b16 v[76:77], v29 offset:3072
    ds_read_b64_tr_b16 v[78:79], v29 offset:3840
    ds_read_b64_tr_b16 v[80:81], v29 offset:3136
    ds_read_b64_tr_b16 v[82:83], v29 offset:3904
    ds_read_b64_tr_b16 v[84:85], v29 offset:3200
    ds_read_b64_tr_b16 v[86:87], v29 offset:3968
    s_waitcnt lgkmcnt(7)
    v_mfma_f32_32x32x16_bf16 v[88:103], v[56:59], v[64:67], v[88:103]
    s_add_u32 m0, s60, 0
    s_add_u32 s63, s58, 384
    buffer_load_dwordx4 v10, s[36:39], s63 offen lds
    v_mfma_f32_32x32x16_bf16 v[104:119], v[56:59], v[68:71], v[104:119]
    s_add_u32 m0, s60, 1024
    s_add_u32 s63, s58, 8576
    buffer_load_dwordx4 v11, s[36:39], s63 offen lds
    v_mfma_f32_32x32x16_bf16 v[120:135], v[56:59], v[72:75], v[120:135]
    ds_read_b128 v[56:59], v22
    ds_read_b64_tr_b16 v[64:65], v29 offset:6144
    ds_read_b64_tr_b16 v[66:67], v29 offset:6912
    ds_read_b64_tr_b16 v[68:69], v29 offset:6208
    ds_read_b64_tr_b16 v[70:71], v29 offset:6976
    ds_read_b64_tr_b16 v[72:73], v29 offset:6272
    ds_read_b64_tr_b16 v[74:75], v29 offset:7040
    s_waitcnt lgkmcnt(7)
    v_mfma_f32_32x32x16_bf16 v[88:103], v[60:63], v[76:79], v[88:103]
    s_add_u32 m0, s60, 2048
    s_add_u32 s63, s58, 16768
    buffer_load_dwordx4 v10, s[36:39], s63 offen lds
    v_mfma_f32_32x32x16_bf16 v[104:119], v[60:63], v[80:83], v[104:119]
    s_add_u32 m0, s60, 3072
    s_add_u32 s63, s58, 24960
    buffer_load_dwordx4 v11, s[36:39], s63 offen lds
    v_mfma_f32_32x32x16_bf16 v[120:135], v[60:63], v[84:87], v[120:135]
    ds_read_b128 v[60:63], v23
    ds_read_b64_tr_b16 v[76:77], v29 offset:9216
    ds_read_b64_tr_b16 v[78:79], v29 offset:9984
    ds_read_b64_tr_b16 v[80:81], v29 offset:9280
    ds_read_b64_tr_b16 v[82:83], v29 offset:10048
    ds_read_b64_tr_b16 v[84:85], v29 offset:9344
    ds_read_b64_tr_b16 v[86:87], v29 offset:10112
    s_waitcnt lgkmcnt(7)
    v_mfma_f32_32x32x16_bf16 v[88:103], v[56:59], v[64:67], v[88:103]
    s_mul_i32 s63, s62, 3
    s_add_u32 m0, s61, 0
    s_nop 0
    buffer_load_dwordx4 v12, s[40:43], s63 offen lds
    v_mfma_f32_32x32x16_bf16 v[104:119], v[56:59], v[68:71], v[104:119]
    s_mul_i32 s63, s62, 3
    s_add_u32 m0, s57, 0
    s_nop 0
    buffer_load_dwordx4 v13, s[40:43], s63 offen lds
    v_mfma_f32_32x32x16_bf16 v[120:135], v[56:59], v[72:75], v[120:135]
    s_waitcnt lgkmcnt(0)
    v_mfma_f32_32x32x16_bf16 v[88:103], v[60:63], v[76:79], v[88:103]
    v_mfma_f32_32x32x16_bf16 v[104:119], v[60:63], v[80:83], v[104:119]
    v_mfma_f32_32x32x16_bf16 v[120:135], v[60:63], v[84:87], v[120:135]
    s_waitcnt vmcnt(6)
    s_barrier
    ds_read_b128 v[56:59], v24
    ds_read_b64_tr_b16 v[64:65], v30 offset:0
    ds_read_b64_tr_b16 v[66:67], v30 offset:768
    ds_read_b64_tr_b16 v[68:69], v30 offset:64
    ds_read_b64_tr_b16 v[70:71], v30 offset:832
    ds_read_b64_tr_b16 v[72:73], v30 offset:128
    ds_read_b64_tr_b16 v[74:75], v30 offset:896
    ds_read_b128 v[60:63], v25
    ds_read_b64_tr_b16 v[76:77], v30 offset:3072
    ds_read_b64_tr_b16 v[78:79], v30 offset:3840
    ds_read_b64_tr_b16 v[80:81], v30 offset:3136
    ds_read_b64_tr_b16 v[82:83], v30 offset:3904
    ds_read_b64_tr_b16 v[84:85], v30 offset:3200
    ds_read_b64_tr_b16 v[86:87], v30 offset:3968
    s_waitcnt lgkmcnt(7)
    v_mfma_f32_32x32x16_bf16 v[88:103], v[56:59], v[64:67], v[88:103]
    s_add_u32 m0, s60, 45056
    s_add_u32 s63, s58, 512
    buffer_load_dwordx4 v10, s[36:39], s63 offen lds
    v_mfma_f32_32x32x16_bf16 v[104:119], v[56:59], v[68:71], v[104:119]
    s_add_u32 m0, s60, 46080
    s_add_u32 s63, s58, 8704
    buffer_load_dwordx4 v11, s[36:39], s63 offen lds
    v_mfma_f32_32x32x16_bf16 v[120:135], v[56:59], v[72:75], v[120:135]
    ds_read_b128 v[56:59], v26
    ds_read_b64_tr_b16 v[64:65], v30 offset:6144
    ds_read_b64_tr_b16 v[66:67], v30 offset:6912
    ds_read_b64_tr_b16 v[68:69], v30 offset:6208
    ds_read_b64_tr_b16 v[70:71], v30 offset:6976
    ds_read_b64_tr_b16 v[72:73], v30 offset:6272
    ds_read_b64_tr_b16 v[74:75], v30 offset:7040
    s_waitcnt lgkmcnt(7)
    v_mfma_f32_32x32x16_bf16 v[88:103], v[60:63], v[76:79], v[88:103]
    s_add_u32 m0, s60, 47104
    s_add_u32 s63, s58, 16896
    buffer_load_dwordx4 v10, s[36:39], s63 offen lds
    v_mfma_f32_32x32x16_bf16 v[104:119], v[60:63], v[80:83], v[104:119]
    s_add_u32 m0, s60, 48128
    s_add_u32 s63, s58, 25088
    buffer_load_dwordx4 v11, s[36:39], s63 offen lds
    v_mfma_f32_32x32x16_bf16 v[120:135], v[60:63], v[84:87], v[120:135]
    ds_read_b128 v[60:63], v27
    ds_read_b64_tr_b16 v[76:77], v30 offset:9216
    ds_read_b64_tr_b16 v[78:79], v30 offset:9984
    ds_read_b64_tr_b16 v[80:81], v30 offset:9280
    ds_read_b64_tr_b16 v[82:83], v30 offset:10048
    ds_read_b64_tr_b16 v[84:85], v30 offset:9344
    ds_read_b64_tr_b16 v[86:87], v30 offset:10112
    s_waitcnt lgkmcnt(7)
    v_mfma_f32_32x32x16_bf16 v[88:103], v[56:59], v[64:67], v[88:103]
    s_mul_i32 s63, s62, 4
    s_add_u32 m0, s61, 45056
    s_nop 0
    buffer_load_dwordx4 v12, s[40:43], s63 offen lds
    v_mfma_f32_32x32x16_bf16 v[104:119], v[56:59], v[68:71], v[104:119]
    s_mul_i32 s63, s62, 4
    s_add_u32 m0, s57, 45056
    s_nop 0
    buffer_load_dwordx4 v13, s[40:43], s63 offen lds
    v_mfma_f32_32x32x16_bf16 v[120:135], v[56:59], v[72:75], v[120:135]
    s_waitcnt lgkmcnt(0)
    v_mfma_f32_32x32x16_bf16 v[88:103], v[60:63], v[76:79], v[88:103]
    v_mfma_f32_32x32x16_bf16 v[104:119], v[60:63], v[80:83], v[104:119]
    v_mfma_f32_32x32x16_bf16 v[120:135], v[60:63], v[84:87], v[120:135]
    s_waitcnt vmcnt(6)
    s_barrier
    ds_read_b128 v[56:59], v16
    ds_read_b64_tr_b16 v[64:65], v28 offset:0
    ds_read_b64_tr_b16 v[66:67], v28 offset:768
    ds_read_b64_tr_b16 v[68:69], v28 offset:64
    ds_read_b64_tr_b16 v[70:71], v28 offset:832
    ds_read_b64_tr_b16 v[72:73], v28 offset:128
    ds_read_b64_tr_b16 v[74:75], v28 offset:896
    ds_read_b128 v[60:63], v17
    ds_read_b64_tr_b16 v[76:77], v28 offset:3072
    ds_read_b64_tr_b16 v[78:79], v28 offset:3840
    ds_read_b64_tr_b16 v[80:81], v28 offset:3136
    ds_read_b64_tr_b16 v[82:83], v28 offset:3904
    ds_read_b64_tr_b16 v[84:85], v28 offset:3200
    ds_read_b64_tr_b16 v[86:87], v28 offset:3968
    s_waitcnt lgkmcnt(7)
    v_mfma_f32_32x32x16_bf16 v[88:103], v[56:59], v[64:67], v[88:103]
    s_add_u32 m0, s60, 90112
    s_add_u32 s63, s58, 640
    buffer_load_dwordx4 v10, s[36:39], s63 offen lds
    v_mfma_f32_32x32x16_bf16 v[104:119], v[56:59], v[68:71], v[104:119]
    s_add_u32 m0, s60, 91136
    s_add_u32 s63, s58, 8832
    buffer_load_dwordx4 v11, s[36:39], s63 offen lds
    v_mfma_f32_32x32x16_bf16 v[120:135], v[56:59], v[72:75], v[120:135]
    ds_read_b128 v[56:59], v18
    ds_read_b64_tr_b16 v[64:65], v28 offset:6144
    ds_read_b64_tr_b16 v[66:67], v28 offset:6912
    ds_read_b64_tr_b16 v[68:69], v28 offset:6208
    ds_read_b64_tr_b16 v[70:71], v28 offset:6976
    ds_read_b64_tr_b16 v[72:73], v28 offset:6272
    ds_read_b64_tr_b16 v[74:75], v28 offset:7040
    s_waitcnt lgkmcnt(7)
    v_mfma_f32_32x32x16_bf16 v[88:103], v[60:63], v[76:79], v[88:103]
    s_add_u32 m0, s60, 92160
    s_add_u32 s63, s58, 17024
    buffer_load_dwordx4 v10, s[36:39], s63 offen lds
    v_mfma_f32_32x32x16_bf16 v[104:119], v[60:63], v[80:83], v[104:119]
    s_add_u32 m0, s60, 93184
    s_add_u32 s63, s58, 25216
    buffer_load_dwordx4 v11, s[36:39], s63 offen lds
    v_mfma_f32_32x32x16_bf16 v[120:135], v[60:63], v[84:87], v[120:135]
    ds_read_b128 v[60:63], v19
    ds_read_b64_tr_b16 v[76:77], v28 offset:9216
    ds_read_b64_tr_b16 v[78:79], v28 offset:9984
    ds_read_b64_tr_b16 v[80:81], v28 offset:9280
    ds_read_b64_tr_b16 v[82:83], v28 offset:10048
    ds_read_b64_tr_b16 v[84:85], v28 offset:9344
    ds_read_b64_tr_b16 v[86:87], v28 offset:10112
    s_waitcnt lgkmcnt(7)
    v_mfma_f32_32x32x16_bf16 v[88:103], v[56:59], v[64:67], v[88:103]
    s_mul_i32 s63, s62, 5
    s_add_u32 m0, s61, 90112
    s_nop 0
    buffer_load_dwordx4 v12, s[40:43], s63 offen lds
    v_mfma_f32_32x32x16_bf16 v[104:119], v[56:59], v[68:71], v[104:119]
    s_mul_i32 s63, s62, 5
    s_add_u32 m0, s57, 90112
    s_nop 0
    buffer_load_dwordx4 v13, s[40:43], s63 offen lds
    v_mfma_f32_32x32x16_bf16 v[120:135], v[56:59], v[72:75], v[120:135]
    s_waitcnt lgkmcnt(0)
    v_mfma_f32_32x32x16_bf16 v[88:103], v[60:63], v[76:79], v[88:103]
    v_mfma_f32_32x32x16_bf16 v[104:119], v[60:63], v[80:83], v[104:119]
    v_mfma_f32_32x32x16_bf16 v[120:135], v[60:63], v[84:87], v[120:135]
    s_waitcnt vmcnt(6)
    s_barrier
    ds_read_b128 v[56:59], v20
    ds_read_b64_tr_b16 v[64:65], v29 offset:0
    ds_read_b64_tr_b16 v[66:67], v29 offset:768
    ds_read_b64_tr_b16 v[68:69], v29 offset:64
    ds_read_b64_tr_b16 v[70:71], v29 offset:832
    ds_read_b64_tr_b16 v[72:73], v29 offset:128
    ds_read_b64_tr_b16 v[74:75], v29 offset:896
    ds_read_b128 v[60:63], v21
    ds_read_b64_tr_b16 v[76:77], v29 offset:3072
    ds_read_b64_tr_b16 v[78:79], v29 offset:3840
    ds_read_b64_tr_b16 v[80:81], v29 offset:3136
    ds_read_b64_tr_b16 v[82:83], v29 offset:3904
    ds_read_b64_tr_b16 v[84:85], v29 offset:3200
    ds_read_b64_tr_b16 v[86:87], v29 offset:3968
    s_waitcnt lgkmcnt(7)
    v_mfma_f32_32x32x16_bf16 v[88:103], v[56:59], v[64:67], v[88:103]
    s_add_u32 m0, s60, 0
    s_add_u32 s63, s58, 768
    buffer_load_dwordx4 v10, s[36:39], s63 offen lds
    v_mfma_f32_32x32x16_bf16 v[104:119], v[56:59], v[68:71], v[104:119]
    s_add_u32 m0, s60, 1024
    s_add_u32 s63, s58, 8960
    buffer_load_dwordx4 v11, s[36:39], s63 offen lds
    v_mfma_f32_32x32x16_bf16 v[120:135], v[56:59], v[72:75], v[120:135]
    ds_read_b128 v[56:59], v22
    ds_read_b64_tr_b16 v[64:65], v29 offset:6144
    ds_read_b64_tr_b16 v[66:67], v29 offset:6912
    ds_read_b64_tr_b16 v[68:69], v29 offset:6208
    ds_read_b64_tr_b16 v[70:71], v29 offset:6976
    ds_read_b64_tr_b16 v[72:73], v29 offset:6272
    ds_read_b64_tr_b16 v[74:75], v29 offset:7040
    s_waitcnt lgkmcnt(7)
    v_mfma_f32_32x32x16_bf16 v[88:103], v[60:63], v[76:79], v[88:103]
    s_add_u32 m0, s60, 2048
    s_add_u32 s63, s58, 17152
    buffer_load_dwordx4 v10, s[36:39], s63 offen lds
    v_mfma_f32_32x32x16_bf16 v[104:119], v[60:63], v[80:83], v[104:119]
    s_add_u32 m0, s60, 3072
    s_add_u32 s63, s58, 25344
    buffer_load_dwordx4 v11, s[36:39], s63 offen lds
    v_mfma_f32_32x32x16_bf16 v[120:135], v[60:63], v[84:87], v[120:135]
    ds_read_b128 v[60:63], v23
    ds_read_b64_tr_b16 v[76:77], v29 offset:9216
    ds_read_b64_tr_b16 v[78:79], v29 offset:9984
    ds_read_b64_tr_b16 v[80:81], v29 offset:9280
    ds_read_b64_tr_b16 v[82:83], v29 offset:10048
    ds_read_b64_tr_b16 v[84:85], v29 offset:9344
    ds_read_b64_tr_b16 v[86:87], v29 offset:10112
    s_waitcnt lgkmcnt(7)
    v_mfma_f32_32x32x16_bf16 v[88:103], v[56:59], v[64:67], v[88:103]
    s_mul_i32 s63, s62, 6
    s_add_u32 m0, s61, 0
    s_nop 0
    buffer_load_dwordx4 v12, s[40:43], s63 offen lds
    v_mfma_f32_32x32x16_bf16 v[104:119], v[56:59], v[68:71], v[104:119]
    s_mul_i32 s63, s62, 6
    s_add_u32 m0, s57, 0
    s_nop 0
    buffer_load_dwordx4 v13, s[40:43], s63 offen lds
    v_mfma_f32_32x32x16_bf16 v[120:135], v[56:59], v[72:75], v[120:135]
    s_waitcnt lgkmcnt(0)
    v_mfma_f32_32x32x16_bf16 v[88:103], v[60:63], v[76:79], v[88:103]
    v_mfma_f32_32x32x16_bf16 v[104:119], v[60:63], v[80:83], v[104:119]
    v_mfma_f32_32x32x16_bf16 v[120:135], v[60:63], v[84:87], v[120:135]
    s_waitcnt vmcnt(6)
    s_barrier
    ds_read_b128 v[56:59], v24
    ds_read_b64_tr_b16 v[64:65], v30 offset:0
    ds_read_b64_tr_b16 v[66:67], v30 offset:768
    ds_read_b64_tr_b16 v[68:69], v30 offset:64
    ds_read_b64_tr_b16 v[70:71], v30 offset:832
    ds_read_b64_tr_b16 v[72:73], v30 offset:128
    ds_read_b64_tr_b16 v[74:75], v30 offset:896
    ds_read_b128 v[60:63], v25
    ds_read_b64_tr_b16 v[76:77], v30 offset:3072
    ds_read_b64_tr_b16 v[78:79], v30 offset:3840
    ds_read_b64_tr_b16 v[80:81], v30 offset:3136
    ds_read_b64_tr_b16 v[82:83], v30 offset:3904
    ds_read_b64_tr_b16 v[84:85], v30 offset:3200
    ds_read_b64_tr_b16 v[86:87], v30 offset:3968
    s_waitcnt lgkmcnt(7)
    v_mfma_f32_32x32x16_bf16 v[88:103], v[56:59], v[64:67], v[88:103]
    s_add_u32 m0, s60, 45056
    s_add_u32 s63, s58, 896
    buffer_load_dwordx4 v10, s[36:39], s63 offen lds
    v_mfma_f32_32x32x16_bf16 v[104:119], v[56:59], v[68:71], v[104:119]
    s_add_u32 m0, s60, 46080
    s_add_u32 s63, s58, 9088
    buffer_load_dwordx4 v11, s[36:39], s63 offen lds
    v_mfma_f32_32x32x16_bf16 v[120:135], v[56:59], v[72:75], v[120:135]
    ds_read_b128 v[56:59], v26
    ds_read_b64_tr_b16 v[64:65], v30 offset:6144
    ds_read_b64_tr_b16 v[66:67], v30 offset:6912
    ds_read_b64_tr_b16 v[68:69], v30 offset:6208
    ds_read_b64_tr_b16 v[70:71], v30 offset:6976
    ds_read_b64_tr_b16 v[72:73], v30 offset:6272
    ds_read_b64_tr_b16 v[74:75], v30 offset:7040
    s_waitcnt lgkmcnt(7)
    v_mfma_f32_32x32x16_bf16 v[88:103], v[60:63], v[76:79], v[88:103]
    s_add_u32 m0, s60, 47104
    s_add_u32 s63, s58, 17280
    buffer_load_dwordx4 v10, s[36:39], s63 offen lds
    v_mfma_f32_32x32x16_bf16 v[104:119], v[60:63], v[80:83], v[104:119]
    s_add_u32 m0, s60, 48128
    s_add_u32 s63, s58, 25472
    buffer_load_dwordx4 v11, s[36:39], s63 offen lds
    v_mfma_f32_32x32x16_bf16 v[120:135], v[60:63], v[84:87], v[120:135]
    ds_read_b128 v[60:63], v27
    ds_read_b64_tr_b16 v[76:77], v30 offset:9216
    ds_read_b64_tr_b16 v[78:79], v30 offset:9984
    ds_read_b64_tr_b16 v[80:81], v30 offset:9280
    ds_read_b64_tr_b16 v[82:83], v30 offset:10048
    ds_read_b64_tr_b16 v[84:85], v30 offset:9344
    ds_read_b64_tr_b16 v[86:87], v30 offset:10112
    s_waitcnt lgkmcnt(7)
    v_mfma_f32_32x32x16_bf16 v[88:103], v[56:59], v[64:67], v[88:103]
    s_mul_i32 s63, s62, 7
    s_add_u32 m0, s61, 45056
    s_nop 0
    buffer_load_dwordx4 v12, s[40:43], s63 offen lds
    v_mfma_f32_32x32x16_bf16 v[104:119], v[56:59], v[68:71], v[104:119]
    s_mul_i32 s63, s62, 7
    s_add_u32 m0, s57, 45056
    s_nop 0
    buffer_load_dwordx4 v13, s[40:43], s63 offen lds
    v_mfma_f32_32x32x16_bf16 v[120:135], v[56:59], v[72:75], v[120:135]
    s_waitcnt lgkmcnt(0)
    v_mfma_f32_32x32x16_bf16 v[88:103], v[60:63], v[76:79], v[88:103]
    v_mfma_f32_32x32x16_bf16 v[104:119], v[60:63], v[80:83], v[104:119]
    v_mfma_f32_32x32x16_bf16 v[120:135], v[60:63], v[84:87], v[120:135]
    s_waitcnt vmcnt(6)
    s_barrier
    ds_read_b128 v[56:59], v16
    ds_read_b64_tr_b16 v[64:65], v28 offset:0
    ds_read_b64_tr_b16 v[66:67], v28 offset:768
    ds_read_b64_tr_b16 v[68:69], v28 offset:64
    ds_read_b64_tr_b16 v[70:71], v28 offset:832
    ds_read_b64_tr_b16 v[72:73], v28 offset:128
    ds_read_b64_tr_b16 v[74:75], v28 offset:896
    ds_read_b128 v[60:63], v17
    ds_read_b64_tr_b16 v[76:77], v28 offset:3072
    ds_read_b64_tr_b16 v[78:79], v28 offset:3840
    ds_read_b64_tr_b16 v[80:81], v28 offset:3136
    ds_read_b64_tr_b16 v[82:83], v28 offset:3904
    ds_read_b64_tr_b16 v[84:85], v28 offset:3200
    ds_read_b64_tr_b16 v[86:87], v28 offset:3968
    s_waitcnt lgkmcnt(7)
    v_mfma_f32_32x32x16_bf16 v[88:103], v[56:59], v[64:67], v[88:103]
    v_mfma_f32_32x32x16_bf16 v[104:119], v[56:59], v[68:71], v[104:119]
    v_mfma_f32_32x32x16_bf16 v[120:135], v[56:59], v[72:75], v[120:135]
    ds_read_b128 v[56:59], v18
    ds_read_b64_tr_b16 v[64:65], v28 offset:6144
    ds_read_b64_tr_b16 v[66:67], v28 offset:6912
    ds_read_b64_tr_b16 v[68:69], v28 offset:6208
    ds_read_b64_tr_b16 v[70:71], v28 offset:6976
    ds_read_b64_tr_b16 v[72:73], v28 offset:6272
    ds_read_b64_tr_b16 v[74:75], v28 offset:7040
    s_waitcnt lgkmcnt(7)
    v_mfma_f32_32x32x16_bf16 v[88:103], v[60:63], v[76:79], v[88:103]
    v_mfma_f32_32x32x16_bf16 v[104:119], v[60:63], v[80:83], v[104:119]
    v_mfma_f32_32x32x16_bf16 v[120:135], v[60:63], v[84:87], v[120:135]
    ds_read_b128 v[60:63], v19
    ds_read_b64_tr_b16 v[76:77], v28 offset:9216
    ds_read_b64_tr_b16 v[78:79], v28 offset:9984
    ds_read_b64_tr_b16 v[80:81], v28 offset:9280
    ds_read_b64_tr_b16 v[82:83], v28 offset:10048
    ds_read_b64_tr_b16 v[84:85], v28 offset:9344
    ds_read_b64_tr_b16 v[86:87], v28 offset:10112
    s_waitcnt lgkmcnt(7)
    v_mfma_f32_32x32x16_bf16 v[88:103], v[56:59], v[64:67], v[88:103]
    v_mfma_f32_32x32x16_bf16 v[104:119], v[56:59], v[68:71], v[104:119]
    v_mfma_f32_32x32x16_bf16 v[120:135], v[56:59], v[72:75], v[120:135]
    s_waitcnt lgkmcnt(0)
    v_mfma_f32_32x32x16_bf16 v[88:103], v[60:63], v[76:79], v[88:103]
    v_mfma_f32_32x32x16_bf16 v[104:119], v[60:63], v[80:83], v[104:119]
    v_mfma_f32_32x32x16_bf16 v[120:135], v[60:63], v[84:87], v[120:135]
    s_waitcnt vmcnt(0)
    s_barrier
    ds_read_b128 v[56:59], v20
    ds_read_b64_tr_b16 v[64:65], v29 offset:0
    ds_read_b64_tr_b16 v[66:67], v29 offset:768
    ds_read_b64_tr_b16 v[68:69], v29 offset:64
    ds_read_b64_tr_b16 v[70:71], v29 offset:832
    ds_read_b64_tr_b16 v[72:73], v29 offset:128
    ds_read_b64_tr_b16 v[74:75], v29 offset:896
    ds_read_b128 v[60:63], v21
    ds_read_b64_tr_b16 v[76:77], v29 offset:3072
    ds_read_b64_tr_b16 v[78:79], v29 offset:3840
    ds_read_b64_tr_b16 v[80:81], v29 offset:3136
    ds_read_b64_tr_b16 v[82:83], v29 offset:3904
    ds_read_b64_tr_b16 v[84:85], v29 offset:3200
    ds_read_b64_tr_b16 v[86:87], v29 offset:3968
    s_waitcnt lgkmcnt(7)
    v_mfma_f32_32x32x16_bf16 v[88:103], v[56:59], v[64:67], v[88:103]
    v_mfma_f32_32x32x16_bf16 v[104:119], v[56:59], v[68:71], v[104:119]
    v_mfma_f32_32x32x16_bf16 v[120:135], v[56:59], v[72:75], v[120:135]
    ds_read_b128 v[56:59], v22
    ds_read_b64_tr_b16 v[64:65], v29 offset:6144
    ds_read_b64_tr_b16 v[66:67], v29 offset:6912
    ds_read_b64_tr_b16 v[68:69], v29 offset:6208
    ds_read_b64_tr_b16 v[70:71], v29 offset:6976
    ds_read_b64_tr_b16 v[72:73], v29 offset:6272
    ds_read_b64_tr_b16 v[74:75], v29 offset:7040
    s_waitcnt lgkmcnt(7)
    v_mfma_f32_32x32x16_bf16 v[88:103], v[60:63], v[76:79], v[88:103]
    v_mfma_f32_32x32x16_bf16 v[104:119], v[60:63], v[80:83], v[104:119]
    v_mfma_f32_32x32x16_bf16 v[120:135], v[60:63], v[84:87], v[120:135]
    ds_read_b128 v[60:63], v23
    ds_read_b64_tr_b16 v[76:77], v29 offset:9216
    ds_read_b64_tr_b16 v[78:79], v29 offset:9984
    ds_read_b64_tr_b16 v[80:81], v29 offset:9280
    ds_read_b64_tr_b16 v[82:83], v29 offset:10048
    ds_read_b64_tr_b16 v[84:85], v29 offset:9344
    ds_read_b64_tr_b16 v[86:87], v29 offset:10112
    s_waitcnt lgkmcnt(7)
    v_mfma_f32_32x32x16_bf16 v[88:103], v[56:59], v[64:67], v[88:103]
    v_mfma_f32_32x32x16_bf16 v[104:119], v[56:59], v[68:71], v[104:119]
    v_mfma_f32_32x32x16_bf16 v[120:135], v[56:59], v[72:75], v[120:135]
    s_waitcnt lgkmcnt(0)
    v_mfma_f32_32x32x16_bf16 v[88:103], v[60:63], v[76:79], v[88:103]
    v_mfma_f32_32x32x16_bf16 v[104:119], v[60:63], v[80:83], v[104:119]
    v_mfma_f32_32x32x16_bf16 v[120:135], v[60:63], v[84:87], v[120:135]
    s_nop 15
    s_nop 3
K1_EPI:
    v_lshlrev_b32 v4, 4, v1
    v_bfe_u32 v5, v1, 4, 1
    v_lshlrev_b32 v5, 16, v5
    v_lshl_add_u32 v5, v3, 8, v5
    v_and_b32 v6, 15, v1
    v_lshl_add_u32 v5, v6, 4, v5
    s_lshl_b32 s64, s5, 3
    s_add_u32 s64, s64, s3
    s_lshl_b32 s65, s64, 10
    s_add_u32 s66, s9, 0
    s_cmp_ge_u32 s4, 16
    s_cbranch_scc1 K1E_1004
    s_and_b32 s67, s66, 15
    s_lshl_b32 s67, s67, 17
    s_add_u32 s68, s65, s67
    s_cmp_lt_u32 s66, 16
    s_cbranch_scc1 K1E_1001
    s_cmp_lt_u32 s66, 32
    s_cbranch_scc1 K1E_1002
K1E_1003:
    v_cvt_pk_bf16_f32 v136, v88, v89
    v_cvt_pk_bf16_f32 v137, v90, v91
    v_cvt_pk_bf16_f32 v138, v92, v93
    v_cvt_pk_bf16_f32 v139, v94, v95
    v_cvt_pk_bf16_f32 v140, v96, v97
    v_cvt_pk_bf16_f32 v141, v98, v99
    v_cvt_pk_bf16_f32 v142, v100, v101
    v_cvt_pk_bf16_f32 v143, v102, v103
    s_add_u32 s68, s68, 8388608
    buffer_store_dwordx4 v[136:139], v5, s[44:47], s68 offen sc1
    buffer_store_dwordx4 v[140:143], v5, s[44:47], s68 offen offset:512 sc1
    s_nop 1
    s_branch K1E_1005
K1E_1002:
    v_cvt_pk_bf16_f32 v136, v88, v89
    v_cvt_pk_bf16_f32 v137, v90, v91
    v_cvt_pk_bf16_f32 v138, v92, v93
    v_cvt_pk_bf16_f32 v139, v94, v95
    v_cvt_pk_bf16_f32 v140, v96, v97
    v_cvt_pk_bf16_f32 v141, v98, v99
    v_cvt_pk_bf16_f32 v142, v100, v101
    v_cvt_pk_bf16_f32 v143, v102, v103
    s_lshl_b32 s71, s64, 2
    s_add_u32 s68, s68, 6291456
    s_add_u32 s69, s68, 65536
    buffer_store_dwordx4 v[136:139], v4, s[44:47], s68 offen sc1
    buffer_store_dwordx4 v[140:143], v4, s[44:47], s69 offen sc1
    v_lshlrev_b32 v148, 16, v136
    v_and_b32 v149, 0xffff0000, v136
    v_mul_f32 v144, v148, v148
    v_fmac_f32 v144, v149, v149
    v_lshlrev_b32 v148, 16, v137
    v_and_b32 v149, 0xffff0000, v137
    v_fmac_f32 v144, v148, v148
    v_fmac_f32 v144, v149, v149
    v_lshlrev_b32 v148, 16, v138
    v_and_b32 v149, 0xffff0000, v138
    v_fmac_f32 v144, v148, v148
    v_fmac_f32 v144, v149, v149
    v_lshlrev_b32 v148, 16, v139
    v_and_b32 v149, 0xffff0000, v139
    v_fmac_f32 v144, v148, v148
    v_fmac_f32 v144, v149, v149
    v_lshlrev_b32 v148, 16, v140
    v_and_b32 v149, 0xffff0000, v140
    v_mul_f32 v145, v148, v148
    v_fmac_f32 v145, v149, v149
    v_lshlrev_b32 v148, 16, v141
    v_and_b32 v149, 0xffff0000, v141
    v_fmac_f32 v145, v148, v148
    v_fmac_f32 v145, v149, v149
    v_lshlrev_b32 v148, 16, v142
    v_and_b32 v149, 0xffff0000, v142
    v_fmac_f32 v145, v148, v148
    v_fmac_f32 v145, v149, v149
    v_lshlrev_b32 v148, 16, v143
    v_and_b32 v149, 0xffff0000, v143
    v_fmac_f32 v145, v148, v148
    v_fmac_f32 v145, v149, v149
    v_mov_b32 v148, v144
    s_nop 1
    v_permlane32_swap_b32 v144, v148
    s_nop 1
    v_add_f32 v144, v144, v148
    s_nop 1
    v_max_f32_dpp v144, v144, v144 quad_perm:[1,0,3,2] row_mask:0xf bank_mask:0xf
    s_nop 1
    v_max_f32_dpp v144, v144, v144 quad_perm:[2,3,0,1] row_mask:0xf bank_mask:0xf
    s_nop 1
    v_max_f32_dpp v144, v144, v144 row_half_mirror row_mask:0xf bank_mask:0xf
    s_nop 1
    v_max_f32_dpp v144, v144, v144 row_mirror row_mask:0xf bank_mask:0xf
    s_nop 1
    v_mov_b32 v148, v144
    s_nop 1
    v_permlane16_swap_b32 v144, v148
    s_nop 1
    v_max_f32 v144, v144, v148
    v_mov_b32 v148, v145
    s_nop 1
    v_permlane32_swap_b32 v145, v148
    s_nop 1
    v_add_f32 v145, v145, v148
    s_nop 1
    v_max_f32_dpp v145, v145, v145 quad_perm:[1,0,3,2] row_mask:0xf bank_mask:0xf
    s_nop 1
    v_max_f32_dpp v145, v145, v145 quad_perm:[2,3,0,1] row_mask:0xf bank_mask:0xf
    s_nop 1
    v_max_f32_dpp v145, v145, v145 row_half_mirror row_mask:0xf bank_mask:0xf
    s_nop 1
    v_max_f32_dpp v145, v145, v145 row_mirror row_mask:0xf bank_mask:0xf
    s_nop 1
    v_mov_b32 v148, v145
    s_nop 1
    v_permlane16_swap_b32 v145, v148
    s_nop 1
    v_max_f32 v145, v145, v148
    s_lshr_b32 s69, s67, 8
    s_add_u32 s71, s71, s69
    s_add_u32 s71, s71, 18939904
    v_mov_b32 v148, 0
    buffer_store_dword v144, v148, s[44:47], s71 offen sc1
    buffer_store_dword v145, v148, s[44:47], s71 offen offset:256 sc1
    s_nop 1
    s_branch K1E_1005
K1E_1001:
    s_mov_b32 s70, 0x3eb8aa3b
    v_cvt_pk_bf16_f32 v136, v88, v89
    v_lshlrev_b32 v88, 16, v136
    v_and_b32 v89, 0xffff0000, v136
    v_mul_f32 v88, s70, v88
    v_mul_f32 v89, s70, v89
    v_cvt_pk_bf16_f32 v136, v88, v89
    v_cvt_pk_bf16_f32 v137, v90, v91
    v_lshlrev_b32 v90, 16, v137
    v_and_b32 v91, 0xffff0000, v137
    v_mul_f32 v90, s70, v90
    v_mul_f32 v91, s70, v91
    v_cvt_pk_bf16_f32 v137, v90, v91
    v_cvt_pk_bf16_f32 v138, v92, v93
    v_lshlrev_b32 v92, 16, v138
    v_and_b32 v93, 0xffff0000, v138
    v_mul_f32 v92, s70, v92
    v_mul_f32 v93, s70, v93
    v_cvt_pk_bf16_f32 v138, v92, v93
    v_cvt_pk_bf16_f32 v139, v94, v95
    v_lshlrev_b32 v94, 16, v139
    v_and_b32 v95, 0xffff0000, v139
    v_mul_f32 v94, s70, v94
    v_mul_f32 v95, s70, v95
    v_cvt_pk_bf16_f32 v139, v94, v95
    v_cvt_pk_bf16_f32 v140, v96, v97
    v_lshlrev_b32 v96, 16, v140
    v_and_b32 v97, 0xffff0000, v140
    v_mul_f32 v96, s70, v96
    v_mul_f32 v97, s70, v97
    v_cvt_pk_bf16_f32 v140, v96, v97
    v_cvt_pk_bf16_f32 v141, v98, v99
    v_lshlrev_b32 v98, 16, v141
    v_and_b32 v99, 0xffff0000, v141
    v_mul_f32 v98, s70, v98
    v_mul_f32 v99, s70, v99
    v_cvt_pk_bf16_f32 v141, v98, v99
    v_cvt_pk_bf16_f32 v142, v100, v101
    v_lshlrev_b32 v100, 16, v142
    v_and_b32 v101, 0xffff0000, v142
    v_mul_f32 v100, s70, v100
    v_mul_f32 v101, s70, v101
    v_cvt_pk_bf16_f32 v142, v100, v101
    v_cvt_pk_bf16_f32 v143, v102, v103
    v_lshlrev_b32 v102, 16, v143
    v_and_b32 v103, 0xffff0000, v143
    v_mul_f32 v102, s70, v102
    v_mul_f32 v103, s70, v103
    v_cvt_pk_bf16_f32 v143, v102, v103
    s_add_u32 s69, s68, 65536
    buffer_store_dwordx4 v[136:139], v4, s[44:47], s68 offen sc1
    buffer_store_dwordx4 v[140:143], v4, s[44:47], s69 offen sc1
    s_nop 1
    s_branch K1E_1005
K1E_1004:
    s_cmp_ge_u32 s66, 43
    s_cbranch_scc1 K1E_1005
    s_mov_b32 s70, 0x3fb8aa3b
    s_mov_b32 s71, 0x41a00000
    v_cvt_pk_bf16_f32 v160, v88, v89
    v_lshlrev_b32 v88, 16, v160
    v_and_b32 v89, 0xffff0000, v160
    v_min_f32 v161, s71, v88
    v_min_f32 v162, s71, v89
    v_mul_f32 v161, s70, v161
    v_mul_f32 v162, s70, v162
    v_exp_f32 v161, v161
    v_exp_f32 v162, v162
    s_nop 0
    v_add_f32 v163, 2.0, v161
    v_add_f32 v164, 2.0, v162
    v_mul_f32 v161, v161, v163
    v_mul_f32 v162, v162, v164
    v_add_f32 v163, 2.0, v161
    v_add_f32 v164, 2.0, v162
    v_rcp_f32 v163, v163
    v_rcp_f32 v164, v164
    v_mul_f32 v88, v88, v161
    v_mul_f32 v89, v89, v162
    v_mul_f32 v88, v88, v163
    v_mul_f32 v89, v89, v164
    v_cvt_pk_bf16_f32 v136, v88, v89
    v_cvt_pk_bf16_f32 v160, v90, v91
    v_lshlrev_b32 v90, 16, v160
    v_and_b32 v91, 0xffff0000, v160
    v_min_f32 v161, s71, v90
    v_min_f32 v162, s71, v91
    v_mul_f32 v161, s70, v161
    v_mul_f32 v162, s70, v162
    v_exp_f32 v161, v161
    v_exp_f32 v162, v162
    s_nop 0
    v_add_f32 v163, 2.0, v161
    v_add_f32 v164, 2.0, v162
    v_mul_f32 v161, v161, v163
    v_mul_f32 v162, v162, v164
    v_add_f32 v163, 2.0, v161
    v_add_f32 v164, 2.0, v162
    v_rcp_f32 v163, v163
    v_rcp_f32 v164, v164
    v_mul_f32 v90, v90, v161
    v_mul_f32 v91, v91, v162
    v_mul_f32 v90, v90, v163
    v_mul_f32 v91, v91, v164
    v_cvt_pk_bf16_f32 v137, v90, v91
    v_cvt_pk_bf16_f32 v160, v92, v93
    v_lshlrev_b32 v92, 16, v160
    v_and_b32 v93, 0xffff0000, v160
    v_min_f32 v161, s71, v92
    v_min_f32 v162, s71, v93
    v_mul_f32 v161, s70, v161
    v_mul_f32 v162, s70, v162
    v_exp_f32 v161, v161
    v_exp_f32 v162, v162
    s_nop 0
    v_add_f32 v163, 2.0, v161
    v_add_f32 v164, 2.0, v162
    v_mul_f32 v161, v161, v163
    v_mul_f32 v162, v162, v164
    v_add_f32 v163, 2.0, v161
    v_add_f32 v164, 2.0, v162
    v_rcp_f32 v163, v163
    v_rcp_f32 v164, v164
    v_mul_f32 v92, v92, v161
    v_mul_f32 v93, v93, v162
    v_mul_f32 v92, v92, v163
    v_mul_f32 v93, v93, v164
    v_cvt_pk_bf16_f32 v138, v92, v93
    v_cvt_pk_bf16_f32 v160, v94, v95
    v_lshlrev_b32 v94, 16, v160
    v_and_b32 v95, 0xffff0000, v160
    v_min_f32 v161, s71, v94
    v_min_f32 v162, s71, v95
    v_mul_f32 v161, s70, v161
    v_mul_f32 v162, s70, v162
    v_exp_f32 v161, v161
    v_exp_f32 v162, v162
    s_nop 0
    v_add_f32 v163, 2.0, v161
    v_add_f32 v164, 2.0, v162
    v_mul_f32 v161, v161, v163
    v_mul_f32 v162, v162, v164
    v_add_f32 v163, 2.0, v161
    v_add_f32 v164, 2.0, v162
    v_rcp_f32 v163, v163
    v_rcp_f32 v164, v164
    v_mul_f32 v94, v94, v161
    v_mul_f32 v95, v95, v162
    v_mul_f32 v94, v94, v163
    v_mul_f32 v95, v95, v164
    v_cvt_pk_bf16_f32 v139, v94, v95
    v_cvt_pk_bf16_f32 v160, v96, v97
    v_lshlrev_b32 v96, 16, v160
    v_and_b32 v97, 0xffff0000, v160
    v_min_f32 v161, s71, v96
    v_min_f32 v162, s71, v97
    v_mul_f32 v161, s70, v161
    v_mul_f32 v162, s70, v162
    v_exp_f32 v161, v161
    v_exp_f32 v162, v162
    s_nop 0
    v_add_f32 v163, 2.0, v161
    v_add_f32 v164, 2.0, v162
    v_mul_f32 v161, v161, v163
    v_mul_f32 v162, v162, v164
    v_add_f32 v163, 2.0, v161
    v_add_f32 v164, 2.0, v162
    v_rcp_f32 v163, v163
    v_rcp_f32 v164, v164
    v_mul_f32 v96, v96, v161
    v_mul_f32 v97, v97, v162
    v_mul_f32 v96, v96, v163
    v_mul_f32 v97, v97, v164
    v_cvt_pk_bf16_f32 v140, v96, v97
    v_cvt_pk_bf16_f32 v160, v98, v99
    v_lshlrev_b32 v98, 16, v160
    v_and_b32 v99, 0xffff0000, v160
    v_min_f32 v161, s71, v98
    v_min_f32 v162, s71, v99
    v_mul_f32 v161, s70, v161
    v_mul_f32 v162, s70, v162
    v_exp_f32 v161, v161
    v_exp_f32 v162, v162
    s_nop 0
    v_add_f32 v163, 2.0, v161
    v_add_f32 v164, 2.0, v162
    v_mul_f32 v161, v161, v163
    v_mul_f32 v162, v162, v164
    v_add_f32 v163, 2.0, v161
    v_add_f32 v164, 2.0, v162
    v_rcp_f32 v163, v163
    v_rcp_f32 v164, v164
    v_mul_f32 v98, v98, v161
    v_mul_f32 v99, v99, v162
    v_mul_f32 v98, v98, v163
    v_mul_f32 v99, v99, v164
    v_cvt_pk_bf16_f32 v141, v98, v99
    v_cvt_pk_bf16_f32 v160, v100, v101
    v_lshlrev_b32 v100, 16, v160
    v_and_b32 v101, 0xffff0000, v160
    v_min_f32 v161, s71, v100
    v_min_f32 v162, s71, v101
    v_mul_f32 v161, s70, v161
    v_mul_f32 v162, s70, v162
    v_exp_f32 v161, v161
    v_exp_f32 v162, v162
    s_nop 0
    v_add_f32 v163, 2.0, v161
    v_add_f32 v164, 2.0, v162
    v_mul_f32 v161, v161, v163
    v_mul_f32 v162, v162, v164
    v_add_f32 v163, 2.0, v161
    v_add_f32 v164, 2.0, v162
    v_rcp_f32 v163, v163
    v_rcp_f32 v164, v164
    v_mul_f32 v100, v100, v161
    v_mul_f32 v101, v101, v162
    v_mul_f32 v100, v100, v163
    v_mul_f32 v101, v101, v164
    v_cvt_pk_bf16_f32 v142, v100, v101
    v_cvt_pk_bf16_f32 v160, v102, v103
    v_lshlrev_b32 v102, 16, v160
    v_and_b32 v103, 0xffff0000, v160
    v_min_f32 v161, s71, v102
    v_min_f32 v162, s71, v103
    v_mul_f32 v161, s70, v161
    v_mul_f32 v162, s70, v162
    v_exp_f32 v161, v161
    v_exp_f32 v162, v162
    s_nop 0
    v_add_f32 v163, 2.0, v161
    v_add_f32 v164, 2.0, v162
    v_mul_f32 v161, v161, v163
    v_mul_f32 v162, v162, v164
    v_add_f32 v163, 2.0, v161
    v_add_f32 v164, 2.0, v162
    v_rcp_f32 v163, v163
    v_rcp_f32 v164, v164
    v_mul_f32 v102, v102, v161
    v_mul_f32 v103, v103, v162
    v_mul_f32 v102, v102, v163
    v_mul_f32 v103, v103, v164
    v_cvt_pk_bf16_f32 v143, v102, v103
    s_mul_i32 s68, s64, 43
    s_add_u32 s68, s68, s66
    s_lshl_b32 s68, s68, 11
    s_add_u32 s68, s68, 10485760
    buffer_store_dwordx4 v[136:139], v4, s[44:47], s68 offen sc1
    buffer_store_dwordx4 v[140:143], v4, s[44:47], s68 offen offset:1024 sc1
    s_nop 1
K1E_1005:
    s_add_u32 s66, s9, 1
    s_cmp_ge_u32 s4, 16
    s_cbranch_scc1 K1E_1009
    s_and_b32 s67, s66, 15
    s_lshl_b32 s67, s67, 17
    s_add_u32 s68, s65, s67
    s_cmp_lt_u32 s66, 16
    s_cbranch_scc1 K1E_1006
    s_cmp_lt_u32 s66, 32
    s_cbranch_scc1 K1E_1007
K1E_1008:
    v_cvt_pk_bf16_f32 v136, v104, v105
    v_cvt_pk_bf16_f32 v137, v106, v107
    v_cvt_pk_bf16_f32 v138, v108, v109
    v_cvt_pk_bf16_f32 v139, v110, v111
    v_cvt_pk_bf16_f32 v140, v112, v113
    v_cvt_pk_bf16_f32 v141, v114, v115
    v_cvt_pk_bf16_f32 v142, v116, v117
    v_cvt_pk_bf16_f32 v143, v118, v119
    s_add_u32 s68, s68, 8388608
    buffer_store_dwordx4 v[136:139], v5, s[44:47], s68 offen sc1
    buffer_store_dwordx4 v[140:143], v5, s[44:47], s68 offen offset:512 sc1
    s_nop 1
    s_branch K1E_1010
K1E_1007:
    v_cvt_pk_bf16_f32 v136, v104, v105
    v_cvt_pk_bf16_f32 v137, v106, v107
    v_cvt_pk_bf16_f32 v138, v108, v109
    v_cvt_pk_bf16_f32 v139, v110, v111
    v_cvt_pk_bf16_f32 v140, v112, v113
    v_cvt_pk_bf16_f32 v141, v114, v115
    v_cvt_pk_bf16_f32 v142, v116, v117
    v_cvt_pk_bf16_f32 v143, v118, v119
    s_lshl_b32 s71, s64, 2
    s_add_u32 s68, s68, 6291456
    s_add_u32 s69, s68, 65536
    buffer_store_dwordx4 v[136:139], v4, s[44:47], s68 offen sc1
    buffer_store_dwordx4 v[140:143], v4, s[44:47], s69 offen sc1
    v_lshlrev_b32 v148, 16, v136
    v_and_b32 v149, 0xffff0000, v136
    v_mul_f32 v144, v148, v148
    v_fmac_f32 v144, v149, v149
    v_lshlrev_b32 v148, 16, v137
    v_and_b32 v149, 0xffff0000, v137
    v_fmac_f32 v144, v148, v148
    v_fmac_f32 v144, v149, v149
    v_lshlrev_b32 v148, 16, v138
    v_and_b32 v149, 0xffff0000, v138
    v_fmac_f32 v144, v148, v148
    v_fmac_f32 v144, v149, v149
    v_lshlrev_b32 v148, 16, v139
    v_and_b32 v149, 0xffff0000, v139
    v_fmac_f32 v144, v148, v148
    v_fmac_f32 v144, v149, v149
    v_lshlrev_b32 v148, 16, v140
    v_and_b32 v149, 0xffff0000, v140
    v_mul_f32 v145, v148, v148
    v_fmac_f32 v145, v149, v149
    v_lshlrev_b32 v148, 16, v141
    v_and_b32 v149, 0xffff0000, v141
    v_fmac_f32 v145, v148, v148
    v_fmac_f32 v145, v149, v149
    v_lshlrev_b32 v148, 16, v142
    v_and_b32 v149, 0xffff0000, v142
    v_fmac_f32 v145, v148, v148
    v_fmac_f32 v145, v149, v149
    v_lshlrev_b32 v148, 16, v143
    v_and_b32 v149, 0xffff0000, v143
    v_fmac_f32 v145, v148, v148
    v_fmac_f32 v145, v149, v149
    v_mov_b32 v148, v144
    s_nop 1
    v_permlane32_swap_b32 v144, v148
    s_nop 1
    v_add_f32 v144, v144, v148
    s_nop 1
    v_max_f32_dpp v144, v144, v144 quad_perm:[1,0,3,2] row_mask:0xf bank_mask:0xf
    s_nop 1
    v_max_f32_dpp v144, v144, v144 quad_perm:[2,3,0,1] row_mask:0xf bank_mask:0xf
    s_nop 1
    v_max_f32_dpp v144, v144, v144 row_half_mirror row_mask:0xf bank_mask:0xf
    s_nop 1
    v_max_f32_dpp v144, v144, v144 row_mirror row_mask:0xf bank_mask:0xf
    s_nop 1
    v_mov_b32 v148, v144
    s_nop 1
    v_permlane16_swap_b32 v144, v148
    s_nop 1
    v_max_f32 v144, v144, v148
    v_mov_b32 v148, v145
    s_nop 1
    v_permlane32_swap_b32 v145, v148
    s_nop 1
    v_add_f32 v145, v145, v148
    s_nop 1
    v_max_f32_dpp v145, v145, v145 quad_perm:[1,0,3,2] row_mask:0xf bank_mask:0xf
    s_nop 1
    v_max_f32_dpp v145, v145, v145 quad_perm:[2,3,0,1] row_mask:0xf bank_mask:0xf
    s_nop 1
    v_max_f32_dpp v145, v145, v145 row_half_mirror row_mask:0xf bank_mask:0xf
    s_nop 1
    v_max_f32_dpp v145, v145, v145 row_mirror row_mask:0xf bank_mask:0xf
    s_nop 1
    v_mov_b32 v148, v145
    s_nop 1
    v_permlane16_swap_b32 v145, v148
    s_nop 1
    v_max_f32 v145, v145, v148
    s_lshr_b32 s69, s67, 8
    s_add_u32 s71, s71, s69
    s_add_u32 s71, s71, 18939904
    v_mov_b32 v148, 0
    buffer_store_dword v144, v148, s[44:47], s71 offen sc1
    buffer_store_dword v145, v148, s[44:47], s71 offen offset:256 sc1
    s_nop 1
    s_branch K1E_1010
K1E_1006:
    s_mov_b32 s70, 0x3eb8aa3b
    v_cvt_pk_bf16_f32 v136, v104, v105
    v_lshlrev_b32 v104, 16, v136
    v_and_b32 v105, 0xffff0000, v136
    v_mul_f32 v104, s70, v104
    v_mul_f32 v105, s70, v105
    v_cvt_pk_bf16_f32 v136, v104, v105
    v_cvt_pk_bf16_f32 v137, v106, v107
    v_lshlrev_b32 v106, 16, v137
    v_and_b32 v107, 0xffff0000, v137
    v_mul_f32 v106, s70, v106
    v_mul_f32 v107, s70, v107
    v_cvt_pk_bf16_f32 v137, v106, v107
    v_cvt_pk_bf16_f32 v138, v108, v109
    v_lshlrev_b32 v108, 16, v138
    v_and_b32 v109, 0xffff0000, v138
    v_mul_f32 v108, s70, v108
    v_mul_f32 v109, s70, v109
    v_cvt_pk_bf16_f32 v138, v108, v109
    v_cvt_pk_bf16_f32 v139, v110, v111
    v_lshlrev_b32 v110, 16, v139
    v_and_b32 v111, 0xffff0000, v139
    v_mul_f32 v110, s70, v110
    v_mul_f32 v111, s70, v111
    v_cvt_pk_bf16_f32 v139, v110, v111
    v_cvt_pk_bf16_f32 v140, v112, v113
    v_lshlrev_b32 v112, 16, v140
    v_and_b32 v113, 0xffff0000, v140
    v_mul_f32 v112, s70, v112
    v_mul_f32 v113, s70, v113
    v_cvt_pk_bf16_f32 v140, v112, v113
    v_cvt_pk_bf16_f32 v141, v114, v115
    v_lshlrev_b32 v114, 16, v141
    v_and_b32 v115, 0xffff0000, v141
    v_mul_f32 v114, s70, v114
    v_mul_f32 v115, s70, v115
    v_cvt_pk_bf16_f32 v141, v114, v115
    v_cvt_pk_bf16_f32 v142, v116, v117
    v_lshlrev_b32 v116, 16, v142
    v_and_b32 v117, 0xffff0000, v142
    v_mul_f32 v116, s70, v116
    v_mul_f32 v117, s70, v117
    v_cvt_pk_bf16_f32 v142, v116, v117
    v_cvt_pk_bf16_f32 v143, v118, v119
    v_lshlrev_b32 v118, 16, v143
    v_and_b32 v119, 0xffff0000, v143
    v_mul_f32 v118, s70, v118
    v_mul_f32 v119, s70, v119
    v_cvt_pk_bf16_f32 v143, v118, v119
    s_add_u32 s69, s68, 65536
    buffer_store_dwordx4 v[136:139], v4, s[44:47], s68 offen sc1
    buffer_store_dwordx4 v[140:143], v4, s[44:47], s69 offen sc1
    s_nop 1
    s_branch K1E_1010
K1E_1009:
    s_cmp_ge_u32 s66, 43
    s_cbranch_scc1 K1E_1010
    s_mov_b32 s70, 0x3fb8aa3b
    s_mov_b32 s71, 0x41a00000
    v_cvt_pk_bf16_f32 v160, v104, v105
    v_lshlrev_b32 v104, 16, v160
    v_and_b32 v105, 0xffff0000, v160
    v_min_f32 v161, s71, v104
    v_min_f32 v162, s71, v105
    v_mul_f32 v161, s70, v161
    v_mul_f32 v162, s70, v162
    v_exp_f32 v161, v161
    v_exp_f32 v162, v162
    s_nop 0
    v_add_f32 v163, 2.0, v161
    v_add_f32 v164, 2.0, v162
    v_mul_f32 v161, v161, v163
    v_mul_f32 v162, v162, v164
    v_add_f32 v163, 2.0, v161
    v_add_f32 v164, 2.0, v162
    v_rcp_f32 v163, v163
    v_rcp_f32 v164, v164
    v_mul_f32 v104, v104, v161
    v_mul_f32 v105, v105, v162
    v_mul_f32 v104, v104, v163
    v_mul_f32 v105, v105, v164
    v_cvt_pk_bf16_f32 v136, v104, v105
    v_cvt_pk_bf16_f32 v160, v106, v107
    v_lshlrev_b32 v106, 16, v160
    v_and_b32 v107, 0xffff0000, v160
    v_min_f32 v161, s71, v106
    v_min_f32 v162, s71, v107
    v_mul_f32 v161, s70, v161
    v_mul_f32 v162, s70, v162
    v_exp_f32 v161, v161
    v_exp_f32 v162, v162
    s_nop 0
    v_add_f32 v163, 2.0, v161
    v_add_f32 v164, 2.0, v162
    v_mul_f32 v161, v161, v163
    v_mul_f32 v162, v162, v164
    v_add_f32 v163, 2.0, v161
    v_add_f32 v164, 2.0, v162
    v_rcp_f32 v163, v163
    v_rcp_f32 v164, v164
    v_mul_f32 v106, v106, v161
    v_mul_f32 v107, v107, v162
    v_mul_f32 v106, v106, v163
    v_mul_f32 v107, v107, v164
    v_cvt_pk_bf16_f32 v137, v106, v107
    v_cvt_pk_bf16_f32 v160, v108, v109
    v_lshlrev_b32 v108, 16, v160
    v_and_b32 v109, 0xffff0000, v160
    v_min_f32 v161, s71, v108
    v_min_f32 v162, s71, v109
    v_mul_f32 v161, s70, v161
    v_mul_f32 v162, s70, v162
    v_exp_f32 v161, v161
    v_exp_f32 v162, v162
    s_nop 0
    v_add_f32 v163, 2.0, v161
    v_add_f32 v164, 2.0, v162
    v_mul_f32 v161, v161, v163
    v_mul_f32 v162, v162, v164
    v_add_f32 v163, 2.0, v161
    v_add_f32 v164, 2.0, v162
    v_rcp_f32 v163, v163
    v_rcp_f32 v164, v164
    v_mul_f32 v108, v108, v161
    v_mul_f32 v109, v109, v162
    v_mul_f32 v108, v108, v163
    v_mul_f32 v109, v109, v164
    v_cvt_pk_bf16_f32 v138, v108, v109
    v_cvt_pk_bf16_f32 v160, v110, v111
    v_lshlrev_b32 v110, 16, v160
    v_and_b32 v111, 0xffff0000, v160
    v_min_f32 v161, s71, v110
    v_min_f32 v162, s71, v111
    v_mul_f32 v161, s70, v161
    v_mul_f32 v162, s70, v162
    v_exp_f32 v161, v161
    v_exp_f32 v162, v162
    s_nop 0
    v_add_f32 v163, 2.0, v161
    v_add_f32 v164, 2.0, v162
    v_mul_f32 v161, v161, v163
    v_mul_f32 v162, v162, v164
    v_add_f32 v163, 2.0, v161
    v_add_f32 v164, 2.0, v162
    v_rcp_f32 v163, v163
    v_rcp_f32 v164, v164
    v_mul_f32 v110, v110, v161
    v_mul_f32 v111, v111, v162
    v_mul_f32 v110, v110, v163
    v_mul_f32 v111, v111, v164
    v_cvt_pk_bf16_f32 v139, v110, v111
    v_cvt_pk_bf16_f32 v160, v112, v113
    v_lshlrev_b32 v112, 16, v160
    v_and_b32 v113, 0xffff0000, v160
    v_min_f32 v161, s71, v112
    v_min_f32 v162, s71, v113
    v_mul_f32 v161, s70, v161
    v_mul_f32 v162, s70, v162
    v_exp_f32 v161, v161
    v_exp_f32 v162, v162
    s_nop 0
    v_add_f32 v163, 2.0, v161
    v_add_f32 v164, 2.0, v162
    v_mul_f32 v161, v161, v163
    v_mul_f32 v162, v162, v164
    v_add_f32 v163, 2.0, v161
    v_add_f32 v164, 2.0, v162
    v_rcp_f32 v163, v163
    v_rcp_f32 v164, v164
    v_mul_f32 v112, v112, v161
    v_mul_f32 v113, v113, v162
    v_mul_f32 v112, v112, v163
    v_mul_f32 v113, v113, v164
    v_cvt_pk_bf16_f32 v140, v112, v113
    v_cvt_pk_bf16_f32 v160, v114, v115
    v_lshlrev_b32 v114, 16, v160
    v_and_b32 v115, 0xffff0000, v160
    v_min_f32 v161, s71, v114
    v_min_f32 v162, s71, v115
    v_mul_f32 v161, s70, v161
    v_mul_f32 v162, s70, v162
    v_exp_f32 v161, v161
    v_exp_f32 v162, v162
    s_nop 0
    v_add_f32 v163, 2.0, v161
    v_add_f32 v164, 2.0, v162
    v_mul_f32 v161, v161, v163
    v_mul_f32 v162, v162, v164
    v_add_f32 v163, 2.0, v161
    v_add_f32 v164, 2.0, v162
    v_rcp_f32 v163, v163
    v_rcp_f32 v164, v164
    v_mul_f32 v114, v114, v161
    v_mul_f32 v115, v115, v162
    v_mul_f32 v114, v114, v163
    v_mul_f32 v115, v115, v164
    v_cvt_pk_bf16_f32 v141, v114, v115
    v_cvt_pk_bf16_f32 v160, v116, v117
    v_lshlrev_b32 v116, 16, v160
    v_and_b32 v117, 0xffff0000, v160
    v_min_f32 v161, s71, v116
    v_min_f32 v162, s71, v117
    v_mul_f32 v161, s70, v161
    v_mul_f32 v162, s70, v162
    v_exp_f32 v161, v161
    v_exp_f32 v162, v162
    s_nop 0
    v_add_f32 v163, 2.0, v161
    v_add_f32 v164, 2.0, v162
    v_mul_f32 v161, v161, v163
    v_mul_f32 v162, v162, v164
    v_add_f32 v163, 2.0, v161
    v_add_f32 v164, 2.0, v162
    v_rcp_f32 v163, v163
    v_rcp_f32 v164, v164
    v_mul_f32 v116, v116, v161
    v_mul_f32 v117, v117, v162
    v_mul_f32 v116, v116, v163
    v_mul_f32 v117, v117, v164
    v_cvt_pk_bf16_f32 v142, v116, v117
    v_cvt_pk_bf16_f32 v160, v118, v119
    v_lshlrev_b32 v118, 16, v160
    v_and_b32 v119, 0xffff0000, v160
    v_min_f32 v161, s71, v118
    v_min_f32 v162, s71, v119
    v_mul_f32 v161, s70, v161
    v_mul_f32 v162, s70, v162
    v_exp_f32 v161, v161
    v_exp_f32 v162, v162
    s_nop 0
    v_add_f32 v163, 2.0, v161
    v_add_f32 v164, 2.0, v162
    v_mul_f32 v161, v161, v163
    v_mul_f32 v162, v162, v164
    v_add_f32 v163, 2.0, v161
    v_add_f32 v164, 2.0, v162
    v_rcp_f32 v163, v163
    v_rcp_f32 v164, v164
    v_mul_f32 v118, v118, v161
    v_mul_f32 v119, v119, v162
    v_mul_f32 v118, v118, v163
    v_mul_f32 v119, v119, v164
    v_cvt_pk_bf16_f32 v143, v118, v119
    s_mul_i32 s68, s64, 43
    s_add_u32 s68, s68, s66
    s_lshl_b32 s68, s68, 11
    s_add_u32 s68, s68, 10485760
    buffer_store_dwordx4 v[136:139], v4, s[44:47], s68 offen sc1
    buffer_store_dwordx4 v[140:143], v4, s[44:47], s68 offen offset:1024 sc1
    s_nop 1
K1E_1010:
    s_add_u32 s66, s9, 2
    s_cmp_ge_u32 s4, 16
    s_cbranch_scc1 K1E_1014
    s_and_b32 s67, s66, 15
    s_lshl_b32 s67, s67, 17
    s_add_u32 s68, s65, s67
    s_cmp_lt_u32 s66, 16
    s_cbranch_scc1 K1E_1011
    s_cmp_lt_u32 s66, 32
    s_cbranch_scc1 K1E_1012
K1E_1013:
    v_cvt_pk_bf16_f32 v136, v120, v121
    v_cvt_pk_bf16_f32 v137, v122, v123
    v_cvt_pk_bf16_f32 v138, v124, v125
    v_cvt_pk_bf16_f32 v139, v126, v127
    v_cvt_pk_bf16_f32 v140, v128, v129
    v_cvt_pk_bf16_f32 v141, v130, v131
    v_cvt_pk_bf16_f32 v142, v132, v133
    v_cvt_pk_bf16_f32 v143, v134, v135
    s_add_u32 s68, s68, 8388608
    buffer_store_dwordx4 v[136:139], v5, s[44:47], s68 offen sc1
    buffer_store_dwordx4 v[140:143], v5, s[44:47], s68 offen offset:512 sc1
    s_nop 1
    s_branch K1E_1015
K1E_1012:
    v_cvt_pk_bf16_f32 v136, v120, v121
    v_cvt_pk_bf16_f32 v137, v122, v123
    v_cvt_pk_bf16_f32 v138, v124, v125
    v_cvt_pk_bf16_f32 v139, v126, v127
    v_cvt_pk_bf16_f32 v140, v128, v129
    v_cvt_pk_bf16_f32 v141, v130, v131
    v_cvt_pk_bf16_f32 v142, v132, v133
    v_cvt_pk_bf16_f32 v143, v134, v135
    s_lshl_b32 s71, s64, 2
    s_add_u32 s68, s68, 6291456
    s_add_u32 s69, s68, 65536
    buffer_store_dwordx4 v[136:139], v4, s[44:47], s68 offen sc1
    buffer_store_dwordx4 v[140:143], v4, s[44:47], s69 offen sc1
    v_lshlrev_b32 v148, 16, v136
    v_and_b32 v149, 0xffff0000, v136
    v_mul_f32 v144, v148, v148
    v_fmac_f32 v144, v149, v149
    v_lshlrev_b32 v148, 16, v137
    v_and_b32 v149, 0xffff0000, v137
    v_fmac_f32 v144, v148, v148
    v_fmac_f32 v144, v149, v149
    v_lshlrev_b32 v148, 16, v138
    v_and_b32 v149, 0xffff0000, v138
    v_fmac_f32 v144, v148, v148
    v_fmac_f32 v144, v149, v149
    v_lshlrev_b32 v148, 16, v139
    v_and_b32 v149, 0xffff0000, v139
    v_fmac_f32 v144, v148, v148
    v_fmac_f32 v144, v149, v149
    v_lshlrev_b32 v148, 16, v140
    v_and_b32 v149, 0xffff0000, v140
    v_mul_f32 v145, v148, v148
    v_fmac_f32 v145, v149, v149
    v_lshlrev_b32 v148, 16, v141
    v_and_b32 v149, 0xffff0000, v141
    v_fmac_f32 v145, v148, v148
    v_fmac_f32 v145, v149, v149
    v_lshlrev_b32 v148, 16, v142
    v_and_b32 v149, 0xffff0000, v142
    v_fmac_f32 v145, v148, v148
    v_fmac_f32 v145, v149, v149
    v_lshlrev_b32 v148, 16, v143
    v_and_b32 v149, 0xffff0000, v143
    v_fmac_f32 v145, v148, v148
    v_fmac_f32 v145, v149, v149
    v_mov_b32 v148, v144
    s_nop 1
    v_permlane32_swap_b32 v144, v148
    s_nop 1
    v_add_f32 v144, v144, v148
    s_nop 1
    v_max_f32_dpp v144, v144, v144 quad_perm:[1,0,3,2] row_mask:0xf bank_mask:0xf
    s_nop 1
    v_max_f32_dpp v144, v144, v144 quad_perm:[2,3,0,1] row_mask:0xf bank_mask:0xf
    s_nop 1
    v_max_f32_dpp v144, v144, v144 row_half_mirror row_mask:0xf bank_mask:0xf
    s_nop 1
    v_max_f32_dpp v144, v144, v144 row_mirror row_mask:0xf bank_mask:0xf
    s_nop 1
    v_mov_b32 v148, v144
    s_nop 1
    v_permlane16_swap_b32 v144, v148
    s_nop 1
    v_max_f32 v144, v144, v148
    v_mov_b32 v148, v145
    s_nop 1
    v_permlane32_swap_b32 v145, v148
    s_nop 1
    v_add_f32 v145, v145, v148
    s_nop 1
    v_max_f32_dpp v145, v145, v145 quad_perm:[1,0,3,2] row_mask:0xf bank_mask:0xf
    s_nop 1
    v_max_f32_dpp v145, v145, v145 quad_perm:[2,3,0,1] row_mask:0xf bank_mask:0xf
    s_nop 1
    v_max_f32_dpp v145, v145, v145 row_half_mirror row_mask:0xf bank_mask:0xf
    s_nop 1
    v_max_f32_dpp v145, v145, v145 row_mirror row_mask:0xf bank_mask:0xf
    s_nop 1
    v_mov_b32 v148, v145
    s_nop 1
    v_permlane16_swap_b32 v145, v148
    s_nop 1
    v_max_f32 v145, v145, v148
    s_lshr_b32 s69, s67, 8
    s_add_u32 s71, s71, s69
    s_add_u32 s71, s71, 18939904
    v_mov_b32 v148, 0
    buffer_store_dword v144, v148, s[44:47], s71 offen sc1
    buffer_store_dword v145, v148, s[44:47], s71 offen offset:256 sc1
    s_nop 1
    s_branch K1E_1015
K1E_1011:
    s_mov_b32 s70, 0x3eb8aa3b
    v_cvt_pk_bf16_f32 v136, v120, v121
    v_lshlrev_b32 v120, 16, v136
    v_and_b32 v121, 0xffff0000, v136
    v_mul_f32 v120, s70, v120
    v_mul_f32 v121, s70, v121
    v_cvt_pk_bf16_f32 v136, v120, v121
    v_cvt_pk_bf16_f32 v137, v122, v123
    v_lshlrev_b32 v122, 16, v137
    v_and_b32 v123, 0xffff0000, v137
    v_mul_f32 v122, s70, v122
    v_mul_f32 v123, s70, v123
    v_cvt_pk_bf16_f32 v137, v122, v123
    v_cvt_pk_bf16_f32 v138, v124, v125
    v_lshlrev_b32 v124, 16, v138
    v_and_b32 v125, 0xffff0000, v138
    v_mul_f32 v124, s70, v124
    v_mul_f32 v125, s70, v125
    v_cvt_pk_bf16_f32 v138, v124, v125
    v_cvt_pk_bf16_f32 v139, v126, v127
    v_lshlrev_b32 v126, 16, v139
    v_and_b32 v127, 0xffff0000, v139
    v_mul_f32 v126, s70, v126
    v_mul_f32 v127, s70, v127
    v_cvt_pk_bf16_f32 v139, v126, v127
    v_cvt_pk_bf16_f32 v140, v128, v129
    v_lshlrev_b32 v128, 16, v140
    v_and_b32 v129, 0xffff0000, v140
    v_mul_f32 v128, s70, v128
    v_mul_f32 v129, s70, v129
    v_cvt_pk_bf16_f32 v140, v128, v129
    v_cvt_pk_bf16_f32 v141, v130, v131
    v_lshlrev_b32 v130, 16, v141
    v_and_b32 v131, 0xffff0000, v141
    v_mul_f32 v130, s70, v130
    v_mul_f32 v131, s70, v131
    v_cvt_pk_bf16_f32 v141, v130, v131
    v_cvt_pk_bf16_f32 v142, v132, v133
    v_lshlrev_b32 v132, 16, v142
    v_and_b32 v133, 0xffff0000, v142
    v_mul_f32 v132, s70, v132
    v_mul_f32 v133, s70, v133
    v_cvt_pk_bf16_f32 v142, v132, v133
    v_cvt_pk_bf16_f32 v143, v134, v135
    v_lshlrev_b32 v134, 16, v143
    v_and_b32 v135, 0xffff0000, v143
    v_mul_f32 v134, s70, v134
    v_mul_f32 v135, s70, v135
    v_cvt_pk_bf16_f32 v143, v134, v135
    s_add_u32 s69, s68, 65536
    buffer_store_dwordx4 v[136:139], v4, s[44:47], s68 offen sc1
    buffer_store_dwordx4 v[140:143], v4, s[44:47], s69 offen sc1
    s_nop 1
    s_branch K1E_1015
K1E_1014:
    s_cmp_ge_u32 s66, 43
    s_cbranch_scc1 K1E_1015
    s_mov_b32 s70, 0x3fb8aa3b
    s_mov_b32 s71, 0x41a00000
    v_cvt_pk_bf16_f32 v160, v120, v121
    v_lshlrev_b32 v120, 16, v160
    v_and_b32 v121, 0xffff0000, v160
    v_min_f32 v161, s71, v120
    v_min_f32 v162, s71, v121
    v_mul_f32 v161, s70, v161
    v_mul_f32 v162, s70, v162
    v_exp_f32 v161, v161
    v_exp_f32 v162, v162
    s_nop 0
    v_add_f32 v163, 2.0, v161
    v_add_f32 v164, 2.0, v162
    v_mul_f32 v161, v161, v163
    v_mul_f32 v162, v162, v164
    v_add_f32 v163, 2.0, v161
    v_add_f32 v164, 2.0, v162
    v_rcp_f32 v163, v163
    v_rcp_f32 v164, v164
    v_mul_f32 v120, v120, v161
    v_mul_f32 v121, v121, v162
    v_mul_f32 v120, v120, v163
    v_mul_f32 v121, v121, v164
    v_cvt_pk_bf16_f32 v136, v120, v121
    v_cvt_pk_bf16_f32 v160, v122, v123
    v_lshlrev_b32 v122, 16, v160
    v_and_b32 v123, 0xffff0000, v160
    v_min_f32 v161, s71, v122
    v_min_f32 v162, s71, v123
    v_mul_f32 v161, s70, v161
    v_mul_f32 v162, s70, v162
    v_exp_f32 v161, v161
    v_exp_f32 v162, v162
    s_nop 0
    v_add_f32 v163, 2.0, v161
    v_add_f32 v164, 2.0, v162
    v_mul_f32 v161, v161, v163
    v_mul_f32 v162, v162, v164
    v_add_f32 v163, 2.0, v161
    v_add_f32 v164, 2.0, v162
    v_rcp_f32 v163, v163
    v_rcp_f32 v164, v164
    v_mul_f32 v122, v122, v161
    v_mul_f32 v123, v123, v162
    v_mul_f32 v122, v122, v163
    v_mul_f32 v123, v123, v164
    v_cvt_pk_bf16_f32 v137, v122, v123
    v_cvt_pk_bf16_f32 v160, v124, v125
    v_lshlrev_b32 v124, 16, v160
    v_and_b32 v125, 0xffff0000, v160
    v_min_f32 v161, s71, v124
    v_min_f32 v162, s71, v125
    v_mul_f32 v161, s70, v161
    v_mul_f32 v162, s70, v162
    v_exp_f32 v161, v161
    v_exp_f32 v162, v162
    s_nop 0
    v_add_f32 v163, 2.0, v161
    v_add_f32 v164, 2.0, v162
    v_mul_f32 v161, v161, v163
    v_mul_f32 v162, v162, v164
    v_add_f32 v163, 2.0, v161
    v_add_f32 v164, 2.0, v162
    v_rcp_f32 v163, v163
    v_rcp_f32 v164, v164
    v_mul_f32 v124, v124, v161
    v_mul_f32 v125, v125, v162
    v_mul_f32 v124, v124, v163
    v_mul_f32 v125, v125, v164
    v_cvt_pk_bf16_f32 v138, v124, v125
    v_cvt_pk_bf16_f32 v160, v126, v127
    v_lshlrev_b32 v126, 16, v160
    v_and_b32 v127, 0xffff0000, v160
    v_min_f32 v161, s71, v126
    v_min_f32 v162, s71, v127
    v_mul_f32 v161, s70, v161
    v_mul_f32 v162, s70, v162
    v_exp_f32 v161, v161
    v_exp_f32 v162, v162
    s_nop 0
    v_add_f32 v163, 2.0, v161
    v_add_f32 v164, 2.0, v162
    v_mul_f32 v161, v161, v163
    v_mul_f32 v162, v162, v164
    v_add_f32 v163, 2.0, v161
    v_add_f32 v164, 2.0, v162
    v_rcp_f32 v163, v163
    v_rcp_f32 v164, v164
    v_mul_f32 v126, v126, v161
    v_mul_f32 v127, v127, v162
    v_mul_f32 v126, v126, v163
    v_mul_f32 v127, v127, v164
    v_cvt_pk_bf16_f32 v139, v126, v127
    v_cvt_pk_bf16_f32 v160, v128, v129
    v_lshlrev_b32 v128, 16, v160
    v_and_b32 v129, 0xffff0000, v160
    v_min_f32 v161, s71, v128
    v_min_f32 v162, s71, v129
    v_mul_f32 v161, s70, v161
    v_mul_f32 v162, s70, v162
    v_exp_f32 v161, v161
    v_exp_f32 v162, v162
    s_nop 0
    v_add_f32 v163, 2.0, v161
    v_add_f32 v164, 2.0, v162
    v_mul_f32 v161, v161, v163
    v_mul_f32 v162, v162, v164
    v_add_f32 v163, 2.0, v161
    v_add_f32 v164, 2.0, v162
    v_rcp_f32 v163, v163
    v_rcp_f32 v164, v164
    v_mul_f32 v128, v128, v161
    v_mul_f32 v129, v129, v162
    v_mul_f32 v128, v128, v163
    v_mul_f32 v129, v129, v164
    v_cvt_pk_bf16_f32 v140, v128, v129
    v_cvt_pk_bf16_f32 v160, v130, v131
    v_lshlrev_b32 v130, 16, v160
    v_and_b32 v131, 0xffff0000, v160
    v_min_f32 v161, s71, v130
    v_min_f32 v162, s71, v131
    v_mul_f32 v161, s70, v161
    v_mul_f32 v162, s70, v162
    v_exp_f32 v161, v161
    v_exp_f32 v162, v162
    s_nop 0
    v_add_f32 v163, 2.0, v161
    v_add_f32 v164, 2.0, v162
    v_mul_f32 v161, v161, v163
    v_mul_f32 v162, v162, v164
    v_add_f32 v163, 2.0, v161
    v_add_f32 v164, 2.0, v162
    v_rcp_f32 v163, v163
    v_rcp_f32 v164, v164
    v_mul_f32 v130, v130, v161
    v_mul_f32 v131, v131, v162
    v_mul_f32 v130, v130, v163
    v_mul_f32 v131, v131, v164
    v_cvt_pk_bf16_f32 v141, v130, v131
    v_cvt_pk_bf16_f32 v160, v132, v133
    v_lshlrev_b32 v132, 16, v160
    v_and_b32 v133, 0xffff0000, v160
    v_min_f32 v161, s71, v132
    v_min_f32 v162, s71, v133
    v_mul_f32 v161, s70, v161
    v_mul_f32 v162, s70, v162
    v_exp_f32 v161, v161
    v_exp_f32 v162, v162
    s_nop 0
    v_add_f32 v163, 2.0, v161
    v_add_f32 v164, 2.0, v162
    v_mul_f32 v161, v161, v163
    v_mul_f32 v162, v162, v164
    v_add_f32 v163, 2.0, v161
    v_add_f32 v164, 2.0, v162
    v_rcp_f32 v163, v163
    v_rcp_f32 v164, v164
    v_mul_f32 v132, v132, v161
    v_mul_f32 v133, v133, v162
    v_mul_f32 v132, v132, v163
    v_mul_f32 v133, v133, v164
    v_cvt_pk_bf16_f32 v142, v132, v133
    v_cvt_pk_bf16_f32 v160, v134, v135
    v_lshlrev_b32 v134, 16, v160
    v_and_b32 v135, 0xffff0000, v160
    v_min_f32 v161, s71, v134
    v_min_f32 v162, s71, v135
    v_mul_f32 v161, s70, v161
    v_mul_f32 v162, s70, v162
    v_exp_f32 v161, v161
    v_exp_f32 v162, v162
    s_nop 0
    v_add_f32 v163, 2.0, v161
    v_add_f32 v164, 2.0, v162
    v_mul_f32 v161, v161, v163
    v_mul_f32 v162, v162, v164
    v_add_f32 v163, 2.0, v161
    v_add_f32 v164, 2.0, v162
    v_rcp_f32 v163, v163
    v_rcp_f32 v164, v164
    v_mul_f32 v134, v134, v161
    v_mul_f32 v135, v135, v162
    v_mul_f32 v134, v134, v163
    v_mul_f32 v135, v135, v164
    v_cvt_pk_bf16_f32 v143, v134, v135
    s_mul_i32 s68, s64, 43
    s_add_u32 s68, s68, s66
    s_lshl_b32 s68, s68, 11
    s_add_u32 s68, s68, 10485760
    buffer_store_dwordx4 v[136:139], v4, s[44:47], s68 offen sc1
    buffer_store_dwordx4 v[140:143], v4, s[44:47], s68 offen offset:1024 sc1
    s_nop 1
K1E_1015:
    s_branch K1_END
K1_GATE:
    s_mov_b32 s48, s30
    s_and_b32 s49, s31, 0xffff
    s_mov_b32 s50, 1024
    s_mov_b32 s51, 0x20000
    v_and_b32 v2, 7, v1
    v_lshrrev_b32 v3, 3, v1
    v_lshlrev_b32 v4, 7, v2
    buffer_load_dwordx4 v[32:35], v4, s[48:51], 0 offen offset:0
    buffer_load_dwordx4 v[36:39], v4, s[48:51], 0 offen offset:16
    buffer_load_dwordx4 v[40:43], v4, s[48:51], 0 offen offset:32
    buffer_load_dwordx4 v[44:47], v4, s[48:51], 0 offen offset:48
    buffer_load_dwordx4 v[48:51], v4, s[48:51], 0 offen offset:64
    buffer_load_dwordx4 v[52:55], v4, s[48:51], 0 offen offset:80
    buffer_load_dwordx4 v[56:59], v4, s[48:51], 0 offen offset:96
    buffer_load_dwordx4 v[60:63], v4, s[48:51], 0 offen offset:112
    v_lshl_add_u32 v5, v3, 10, v4
    s_lshl_b32 s58, s5, 18
    s_lshl_b32 s59, s3, 15
    s_add_u32 s58, s58, s59
    s_add_u32 s59, s58, 0
    buffer_load_dwordx4 v[128:131], v5, s[36:39], s59 offen offset:0
    buffer_load_dwordx4 v[132:135], v5, s[36:39], s59 offen offset:16
    buffer_load_dwordx4 v[136:139], v5, s[36:39], s59 offen offset:32
    buffer_load_dwordx4 v[140:143], v5, s[36:39], s59 offen offset:48
    buffer_load_dwordx4 v[144:147], v5, s[36:39], s59 offen offset:64
    buffer_load_dwordx4 v[148:151], v5, s[36:39], s59 offen offset:80
    buffer_load_dwordx4 v[152:155], v5, s[36:39], s59 offen offset:96
    buffer_load_dwordx4 v[156:159], v5, s[36:39], s59 offen offset:112
    s_add_u32 s59, s58, 8192
    buffer_load_dwordx4 v[160:163], v5, s[36:39], s59 offen offset:0
    buffer_load_dwordx4 v[164:167], v5, s[36:39], s59 offen offset:16
    buffer_load_dwordx4 v[168:171], v5, s[36:39], s59 offen offset:32
    buffer_load_dwordx4 v[172:175], v5, s[36:39], s59 offen offset:48
    buffer_load_dwordx4 v[176:179], v5, s[36:39], s59 offen offset:64
    buffer_load_dwordx4 v[180:183], v5, s[36:39], s59 offen offset:80
    buffer_load_dwordx4 v[184:187], v5, s[36:39], s59 offen offset:96
    buffer_load_dwordx4 v[188:191], v5, s[36:39], s59 offen offset:112
    s_waitcnt vmcnt(16)
    v_lshlrev_b32 v64, 16, v32
    v_and_b32 v65, 0xffff0000, v32
    v_lshlrev_b32 v66, 16, v33
    v_and_b32 v67, 0xffff0000, v33
    v_lshlrev_b32 v68, 16, v34
    v_and_b32 v69, 0xffff0000, v34
    v_lshlrev_b32 v70, 16, v35
    v_and_b32 v71, 0xffff0000, v35
    v_lshlrev_b32 v72, 16, v36
    v_and_b32 v73, 0xffff0000, v36
    v_lshlrev_b32 v74, 16, v37
    v_and_b32 v75, 0xffff0000, v37
    v_lshlrev_b32 v76, 16, v38
    v_and_b32 v77, 0xffff0000, v38
    v_lshlrev_b32 v78, 16, v39
    v_and_b32 v79, 0xffff0000, v39
    v_lshlrev_b32 v80, 16, v40
    v_and_b32 v81, 0xffff0000, v40
    v_lshlrev_b32 v82, 16, v41
    v_and_b32 v83, 0xffff0000, v41
    v_lshlrev_b32 v84, 16, v42
    v_and_b32 v85, 0xffff0000, v42
    v_lshlrev_b32 v86, 16, v43
    v_and_b32 v87, 0xffff0000, v43
    v_lshlrev_b32 v88, 16, v44
    v_and_b32 v89, 0xffff0000, v44
    v_lshlrev_b32 v90, 16, v45
    v_and_b32 v91, 0xffff0000, v45
    v_lshlrev_b32 v92, 16, v46
    v_and_b32 v93, 0xffff0000, v46
    v_lshlrev_b32 v94, 16, v47
    v_and_b32 v95, 0xffff0000, v47
    v_lshlrev_b32 v96, 16, v48
    v_and_b32 v97, 0xffff0000, v48
    v_lshlrev_b32 v98, 16, v49
    v_and_b32 v99, 0xffff0000, v49
    v_lshlrev_b32 v100, 16, v50
    v_and_b32 v101, 0xffff0000, v50
    v_lshlrev_b32 v102, 16, v51
    v_and_b32 v103, 0xffff0000, v51
    v_lshlrev_b32 v104, 16, v52
    v_and_b32 v105, 0xffff0000, v52
    v_lshlrev_b32 v106, 16, v53
    v_and_b32 v107, 0xffff0000, v53
    v_lshlrev_b32 v108, 16, v54
    v_and_b32 v109, 0xffff0000, v54
    v_lshlrev_b32 v110, 16, v55
    v_and_b32 v111, 0xffff0000, v55
    v_lshlrev_b32 v112, 16, v56
    v_and_b32 v113, 0xffff0000, v56
    v_lshlrev_b32 v114, 16, v57
    v_and_b32 v115, 0xffff0000, v57
    v_lshlrev_b32 v116, 16, v58
    v_and_b32 v117, 0xffff0000, v58
    v_lshlrev_b32 v118, 16, v59
    v_and_b32 v119, 0xffff0000, v59
    v_lshlrev_b32 v120, 16, v60
    v_and_b32 v121, 0xffff0000, v60
    v_lshlrev_b32 v122, 16, v61
    v_and_b32 v123, 0xffff0000, v61
    v_lshlrev_b32 v124, 16, v62
    v_and_b32 v125, 0xffff0000, v62
    v_lshlrev_b32 v126, 16, v63
    v_and_b32 v127, 0xffff0000, v63
    s_lshl_b32 s60, s5, 10
    s_lshl_b32 s61, s3, 7
    s_add_u32 s60, s60, s61
    s_add_u32 s60, s60, 18874368
    v_lshlrev_b32 v6, 2, v3
    s_mov_b32 s70, 0xbfb8aa3b
    v_mov_b32 v8, 0
    v_mov_b32 v9, 0
    s_waitcnt vmcnt(8)
    v_lshlrev_b32 v10, 16, v128
    v_and_b32 v11, 0xffff0000, v128
    v_mul_f32 v10, v10, v64
    v_mul_f32 v11, v11, v65
    v_cvt_pk_bf16_f32 v12, v10, v11
    v_lshlrev_b32 v10, 16, v12
    v_and_b32 v11, 0xffff0000, v12
    v_add_f32 v8, v8, v10
    v_add_f32 v9, v9, v11
    v_lshlrev_b32 v10, 16, v129
    v_and_b32 v11, 0xffff0000, v129
    v_mul_f32 v10, v10, v66
    v_mul_f32 v11, v11, v67
    v_cvt_pk_bf16_f32 v12, v10, v11
    v_lshlrev_b32 v10, 16, v12
    v_and_b32 v11, 0xffff0000, v12
    v_add_f32 v8, v8, v10
    v_add_f32 v9, v9, v11
    v_lshlrev_b32 v10, 16, v130
    v_and_b32 v11, 0xffff0000, v130
    v_mul_f32 v10, v10, v68
    v_mul_f32 v11, v11, v69
    v_cvt_pk_bf16_f32 v12, v10, v11
    v_lshlrev_b32 v10, 16, v12
    v_and_b32 v11, 0xffff0000, v12
    v_add_f32 v8, v8, v10
    v_add_f32 v9, v9, v11
    v_lshlrev_b32 v10, 16, v131
    v_and_b32 v11, 0xffff0000, v131
    v_mul_f32 v10, v10, v70
    v_mul_f32 v11, v11, v71
    v_cvt_pk_bf16_f32 v12, v10, v11
    v_lshlrev_b32 v10, 16, v12
    v_and_b32 v11, 0xffff0000, v12
    v_add_f32 v8, v8, v10
    v_add_f32 v9, v9, v11
    v_lshlrev_b32 v10, 16, v132
    v_and_b32 v11, 0xffff0000, v132
    v_mul_f32 v10, v10, v72
    v_mul_f32 v11, v11, v73
    v_cvt_pk_bf16_f32 v12, v10, v11
    v_lshlrev_b32 v10, 16, v12
    v_and_b32 v11, 0xffff0000, v12
    v_add_f32 v8, v8, v10
    v_add_f32 v9, v9, v11
    v_lshlrev_b32 v10, 16, v133
    v_and_b32 v11, 0xffff0000, v133
    v_mul_f32 v10, v10, v74
    v_mul_f32 v11, v11, v75
    v_cvt_pk_bf16_f32 v12, v10, v11
    v_lshlrev_b32 v10, 16, v12
    v_and_b32 v11, 0xffff0000, v12
    v_add_f32 v8, v8, v10
    v_add_f32 v9, v9, v11
    v_lshlrev_b32 v10, 16, v134
    v_and_b32 v11, 0xffff0000, v134
    v_mul_f32 v10, v10, v76
    v_mul_f32 v11, v11, v77
    v_cvt_pk_bf16_f32 v12, v10, v11
    v_lshlrev_b32 v10, 16, v12
    v_and_b32 v11, 0xffff0000, v12
    v_add_f32 v8, v8, v10
    v_add_f32 v9, v9, v11
    v_lshlrev_b32 v10, 16, v135
    v_and_b32 v11, 0xffff0000, v135
    v_mul_f32 v10, v10, v78
    v_mul_f32 v11, v11, v79
    v_cvt_pk_bf16_f32 v12, v10, v11
    v_lshlrev_b32 v10, 16, v12
    v_and_b32 v11, 0xffff0000, v12
    v_add_f32 v8, v8, v10
    v_add_f32 v9, v9, v11
    v_lshlrev_b32 v10, 16, v136
    v_and_b32 v11, 0xffff0000, v136
    v_mul_f32 v10, v10, v80
    v_mul_f32 v11, v11, v81
    v_cvt_pk_bf16_f32 v12, v10, v11
    v_lshlrev_b32 v10, 16, v12
    v_and_b32 v11, 0xffff0000, v12
    v_add_f32 v8, v8, v10
    v_add_f32 v9, v9, v11
    v_lshlrev_b32 v10, 16, v137
    v_and_b32 v11, 0xffff0000, v137
    v_mul_f32 v10, v10, v82
    v_mul_f32 v11, v11, v83
    v_cvt_pk_bf16_f32 v12, v10, v11
    v_lshlrev_b32 v10, 16, v12
    v_and_b32 v11, 0xffff0000, v12
    v_add_f32 v8, v8, v10
    v_add_f32 v9, v9, v11
    v_lshlrev_b32 v10, 16, v138
    v_and_b32 v11, 0xffff0000, v138
    v_mul_f32 v10, v10, v84
    v_mul_f32 v11, v11, v85
    v_cvt_pk_bf16_f32 v12, v10, v11
    v_lshlrev_b32 v10, 16, v12
    v_and_b32 v11, 0xffff0000, v12
    v_add_f32 v8, v8, v10
    v_add_f32 v9, v9, v11
    v_lshlrev_b32 v10, 16, v139
    v_and_b32 v11, 0xffff0000, v139
    v_mul_f32 v10, v10, v86
    v_mul_f32 v11, v11, v87
    v_cvt_pk_bf16_f32 v12, v10, v11
    v_lshlrev_b32 v10, 16, v12
    v_and_b32 v11, 0xffff0000, v12
    v_add_f32 v8, v8, v10
    v_add_f32 v9, v9, v11
    v_lshlrev_b32 v10, 16, v140
    v_and_b32 v11, 0xffff0000, v140
    v_mul_f32 v10, v10, v88
    v_mul_f32 v11, v11, v89
    v_cvt_pk_bf16_f32 v12, v10, v11
    v_lshlrev_b32 v10, 16, v12
    v_and_b32 v11, 0xffff0000, v12
    v_add_f32 v8, v8, v10
    v_add_f32 v9, v9, v11
    v_lshlrev_b32 v10, 16, v141
    v_and_b32 v11, 0xffff0000, v141
    v_mul_f32 v10, v10, v90
    v_mul_f32 v11, v11, v91
    v_cvt_pk_bf16_f32 v12, v10, v11
    v_lshlrev_b32 v10, 16, v12
    v_and_b32 v11, 0xffff0000, v12
    v_add_f32 v8, v8, v10
    v_add_f32 v9, v9, v11
    v_lshlrev_b32 v10, 16, v142
    v_and_b32 v11, 0xffff0000, v142
    v_mul_f32 v10, v10, v92
    v_mul_f32 v11, v11, v93
    v_cvt_pk_bf16_f32 v12, v10, v11
    v_lshlrev_b32 v10, 16, v12
    v_and_b32 v11, 0xffff0000, v12
    v_add_f32 v8, v8, v10
    v_add_f32 v9, v9, v11
    v_lshlrev_b32 v10, 16, v143
    v_and_b32 v11, 0xffff0000, v143
    v_mul_f32 v10, v10, v94
    v_mul_f32 v11, v11, v95
    v_cvt_pk_bf16_f32 v12, v10, v11
    v_lshlrev_b32 v10, 16, v12
    v_and_b32 v11, 0xffff0000, v12
    v_add_f32 v8, v8, v10
    v_add_f32 v9, v9, v11
    v_lshlrev_b32 v10, 16, v144
    v_and_b32 v11, 0xffff0000, v144
    v_mul_f32 v10, v10, v96
    v_mul_f32 v11, v11, v97
    v_cvt_pk_bf16_f32 v12, v10, v11
    v_lshlrev_b32 v10, 16, v12
    v_and_b32 v11, 0xffff0000, v12
    v_add_f32 v8, v8, v10
    v_add_f32 v9, v9, v11
    v_lshlrev_b32 v10, 16, v145
    v_and_b32 v11, 0xffff0000, v145
    v_mul_f32 v10, v10, v98
    v_mul_f32 v11, v11, v99
    v_cvt_pk_bf16_f32 v12, v10, v11
    v_lshlrev_b32 v10, 16, v12
    v_and_b32 v11, 0xffff0000, v12
    v_add_f32 v8, v8, v10
    v_add_f32 v9, v9, v11
    v_lshlrev_b32 v10, 16, v146
    v_and_b32 v11, 0xffff0000, v146
    v_mul_f32 v10, v10, v100
    v_mul_f32 v11, v11, v101
    v_cvt_pk_bf16_f32 v12, v10, v11
    v_lshlrev_b32 v10, 16, v12
    v_and_b32 v11, 0xffff0000, v12
    v_add_f32 v8, v8, v10
    v_add_f32 v9, v9, v11
    v_lshlrev_b32 v10, 16, v147
    v_and_b32 v11, 0xffff0000, v147
    v_mul_f32 v10, v10, v102
    v_mul_f32 v11, v11, v103
    v_cvt_pk_bf16_f32 v12, v10, v11
    v_lshlrev_b32 v10, 16, v12
    v_and_b32 v11, 0xffff0000, v12
    v_add_f32 v8, v8, v10
    v_add_f32 v9, v9, v11
    v_lshlrev_b32 v10, 16, v148
    v_and_b32 v11, 0xffff0000, v148
    v_mul_f32 v10, v10, v104
    v_mul_f32 v11, v11, v105
    v_cvt_pk_bf16_f32 v12, v10, v11
    v_lshlrev_b32 v10, 16, v12
    v_and_b32 v11, 0xffff0000, v12
    v_add_f32 v8, v8, v10
    v_add_f32 v9, v9, v11
    v_lshlrev_b32 v10, 16, v149
    v_and_b32 v11, 0xffff0000, v149
    v_mul_f32 v10, v10, v106
    v_mul_f32 v11, v11, v107
    v_cvt_pk_bf16_f32 v12, v10, v11
    v_lshlrev_b32 v10, 16, v12
    v_and_b32 v11, 0xffff0000, v12
    v_add_f32 v8, v8, v10
    v_add_f32 v9, v9, v11
    v_lshlrev_b32 v10, 16, v150
    v_and_b32 v11, 0xffff0000, v150
    v_mul_f32 v10, v10, v108
    v_mul_f32 v11, v11, v109
    v_cvt_pk_bf16_f32 v12, v10, v11
    v_lshlrev_b32 v10, 16, v12
    v_and_b32 v11, 0xffff0000, v12
    v_add_f32 v8, v8, v10
    v_add_f32 v9, v9, v11
    v_lshlrev_b32 v10, 16, v151
    v_and_b32 v11, 0xffff0000, v151
    v_mul_f32 v10, v10, v110
    v_mul_f32 v11, v11, v111
    v_cvt_pk_bf16_f32 v12, v10, v11
    v_lshlrev_b32 v10, 16, v12
    v_and_b32 v11, 0xffff0000, v12
    v_add_f32 v8, v8, v10
    v_add_f32 v9, v9, v11
    v_lshlrev_b32 v10, 16, v152
    v_and_b32 v11, 0xffff0000, v152
    v_mul_f32 v10, v10, v112
    v_mul_f32 v11, v11, v113
    v_cvt_pk_bf16_f32 v12, v10, v11
    v_lshlrev_b32 v10, 16, v12
    v_and_b32 v11, 0xffff0000, v12
    v_add_f32 v8, v8, v10
    v_add_f32 v9, v9, v11
    v_lshlrev_b32 v10, 16, v153
    v_and_b32 v11, 0xffff0000, v153
    v_mul_f32 v10, v10, v114
    v_mul_f32 v11, v11, v115
    v_cvt_pk_bf16_f32 v12, v10, v11
    v_lshlrev_b32 v10, 16, v12
    v_and_b32 v11, 0xffff0000, v12
    v_add_f32 v8, v8, v10
    v_add_f32 v9, v9, v11
    v_lshlrev_b32 v10, 16, v154
    v_and_b32 v11, 0xffff0000, v154
    v_mul_f32 v10, v10, v116
    v_mul_f32 v11, v11, v117
    v_cvt_pk_bf16_f32 v12, v10, v11
    v_lshlrev_b32 v10, 16, v12
    v_and_b32 v11, 0xffff0000, v12
    v_add_f32 v8, v8, v10
    v_add_f32 v9, v9, v11
    v_lshlrev_b32 v10, 16, v155
    v_and_b32 v11, 0xffff0000, v155
    v_mul_f32 v10, v10, v118
    v_mul_f32 v11, v11, v119
    v_cvt_pk_bf16_f32 v12, v10, v11
    v_lshlrev_b32 v10, 16, v12
    v_and_b32 v11, 0xffff0000, v12
    v_add_f32 v8, v8, v10
    v_add_f32 v9, v9, v11
    v_lshlrev_b32 v10, 16, v156
    v_and_b32 v11, 0xffff0000, v156
    v_mul_f32 v10, v10, v120
    v_mul_f32 v11, v11, v121
    v_cvt_pk_bf16_f32 v12, v10, v11
    v_lshlrev_b32 v10, 16, v12
    v_and_b32 v11, 0xffff0000, v12
    v_add_f32 v8, v8, v10
    v_add_f32 v9, v9, v11
    v_lshlrev_b32 v10, 16, v157
    v_and_b32 v11, 0xffff0000, v157
    v_mul_f32 v10, v10, v122
    v_mul_f32 v11, v11, v123
    v_cvt_pk_bf16_f32 v12, v10, v11
    v_lshlrev_b32 v10, 16, v12
    v_and_b32 v11, 0xffff0000, v12
    v_add_f32 v8, v8, v10
    v_add_f32 v9, v9, v11
    v_lshlrev_b32 v10, 16, v158
    v_and_b32 v11, 0xffff0000, v158
    v_mul_f32 v10, v10, v124
    v_mul_f32 v11, v11, v125
    v_cvt_pk_bf16_f32 v12, v10, v11
    v_lshlrev_b32 v10, 16, v12
    v_and_b32 v11, 0xffff0000, v12
    v_add_f32 v8, v8, v10
    v_add_f32 v9, v9, v11
    v_lshlrev_b32 v10, 16, v159
    v_and_b32 v11, 0xffff0000, v159
    v_mul_f32 v10, v10, v126
    v_mul_f32 v11, v11, v127
    v_cvt_pk_bf16_f32 v12, v10, v11
    v_lshlrev_b32 v10, 16, v12
    v_and_b32 v11, 0xffff0000, v12
    v_add_f32 v8, v8, v10
    v_add_f32 v9, v9, v11
    s_add_u32 s59, s58, 16384
    buffer_load_dwordx4 v[128:131], v5, s[36:39], s59 offen offset:0
    buffer_load_dwordx4 v[132:135], v5, s[36:39], s59 offen offset:16
    buffer_load_dwordx4 v[136:139], v5, s[36:39], s59 offen offset:32
    buffer_load_dwordx4 v[140:143], v5, s[36:39], s59 offen offset:48
    buffer_load_dwordx4 v[144:147], v5, s[36:39], s59 offen offset:64
    buffer_load_dwordx4 v[148:151], v5, s[36:39], s59 offen offset:80
    buffer_load_dwordx4 v[152:155], v5, s[36:39], s59 offen offset:96
    buffer_load_dwordx4 v[156:159], v5, s[36:39], s59 offen offset:112
    v_add_f32 v8, v8, v9
    s_nop 1
    v_add_f32_dpp v8, v8, v8 quad_perm:[1,0,3,2] row_mask:0xf bank_mask:0xf
    s_nop 1
    v_add_f32_dpp v8, v8, v8 quad_perm:[2,3,0,1] row_mask:0xf bank_mask:0xf
    s_nop 1
    v_add_f32_dpp v8, v8, v8 row_half_mirror row_mask:0xf bank_mask:0xf
    s_nop 1
    v_cvt_pk_bf16_f32 v9, v8, v8
    v_lshlrev_b32 v8, 16, v9
    v_mul_f32 v8, s70, v8
    v_exp_f32 v8, v8
    s_nop 0
    v_add_f32 v8, 1.0, v8
    v_rcp_f32 v8, v8
    s_nop 0
    v_cvt_pk_bf16_f32 v9, v8, v8
    v_lshlrev_b32 v13, 16, v9
    buffer_store_dword v13, v6, s[44:47], s60 offen offset:0 sc1
    v_mov_b32 v8, 0
    v_mov_b32 v9, 0
    s_waitcnt vmcnt(8)
    v_lshlrev_b32 v10, 16, v160
    v_and_b32 v11, 0xffff0000, v160
    v_mul_f32 v10, v10, v64
    v_mul_f32 v11, v11, v65
    v_cvt_pk_bf16_f32 v12, v10, v11
    v_lshlrev_b32 v10, 16, v12
    v_and_b32 v11, 0xffff0000, v12
    v_add_f32 v8, v8, v10
    v_add_f32 v9, v9, v11
    v_lshlrev_b32 v10, 16, v161
    v_and_b32 v11, 0xffff0000, v161
    v_mul_f32 v10, v10, v66
    v_mul_f32 v11, v11, v67
    v_cvt_pk_bf16_f32 v12, v10, v11
    v_lshlrev_b32 v10, 16, v12
    v_and_b32 v11, 0xffff0000, v12
    v_add_f32 v8, v8, v10
    v_add_f32 v9, v9, v11
    v_lshlrev_b32 v10, 16, v162
    v_and_b32 v11, 0xffff0000, v162
    v_mul_f32 v10, v10, v68
    v_mul_f32 v11, v11, v69
    v_cvt_pk_bf16_f32 v12, v10, v11
    v_lshlrev_b32 v10, 16, v12
    v_and_b32 v11, 0xffff0000, v12
    v_add_f32 v8, v8, v10
    v_add_f32 v9, v9, v11
    v_lshlrev_b32 v10, 16, v163
    v_and_b32 v11, 0xffff0000, v163
    v_mul_f32 v10, v10, v70
    v_mul_f32 v11, v11, v71
    v_cvt_pk_bf16_f32 v12, v10, v11
    v_lshlrev_b32 v10, 16, v12
    v_and_b32 v11, 0xffff0000, v12
    v_add_f32 v8, v8, v10
    v_add_f32 v9, v9, v11
    v_lshlrev_b32 v10, 16, v164
    v_and_b32 v11, 0xffff0000, v164
    v_mul_f32 v10, v10, v72
    v_mul_f32 v11, v11, v73
    v_cvt_pk_bf16_f32 v12, v10, v11
    v_lshlrev_b32 v10, 16, v12
    v_and_b32 v11, 0xffff0000, v12
    v_add_f32 v8, v8, v10
    v_add_f32 v9, v9, v11
    v_lshlrev_b32 v10, 16, v165
    v_and_b32 v11, 0xffff0000, v165
    v_mul_f32 v10, v10, v74
    v_mul_f32 v11, v11, v75
    v_cvt_pk_bf16_f32 v12, v10, v11
    v_lshlrev_b32 v10, 16, v12
    v_and_b32 v11, 0xffff0000, v12
    v_add_f32 v8, v8, v10
    v_add_f32 v9, v9, v11
    v_lshlrev_b32 v10, 16, v166
    v_and_b32 v11, 0xffff0000, v166
    v_mul_f32 v10, v10, v76
    v_mul_f32 v11, v11, v77
    v_cvt_pk_bf16_f32 v12, v10, v11
    v_lshlrev_b32 v10, 16, v12
    v_and_b32 v11, 0xffff0000, v12
    v_add_f32 v8, v8, v10
    v_add_f32 v9, v9, v11
    v_lshlrev_b32 v10, 16, v167
    v_and_b32 v11, 0xffff0000, v167
    v_mul_f32 v10, v10, v78
    v_mul_f32 v11, v11, v79
    v_cvt_pk_bf16_f32 v12, v10, v11
    v_lshlrev_b32 v10, 16, v12
    v_and_b32 v11, 0xffff0000, v12
    v_add_f32 v8, v8, v10
    v_add_f32 v9, v9, v11
    v_lshlrev_b32 v10, 16, v168
    v_and_b32 v11, 0xffff0000, v168
    v_mul_f32 v10, v10, v80
    v_mul_f32 v11, v11, v81
    v_cvt_pk_bf16_f32 v12, v10, v11
    v_lshlrev_b32 v10, 16, v12
    v_and_b32 v11, 0xffff0000, v12
    v_add_f32 v8, v8, v10
    v_add_f32 v9, v9, v11
    v_lshlrev_b32 v10, 16, v169
    v_and_b32 v11, 0xffff0000, v169
    v_mul_f32 v10, v10, v82
    v_mul_f32 v11, v11, v83
    v_cvt_pk_bf16_f32 v12, v10, v11
    v_lshlrev_b32 v10, 16, v12
    v_and_b32 v11, 0xffff0000, v12
    v_add_f32 v8, v8, v10
    v_add_f32 v9, v9, v11
    v_lshlrev_b32 v10, 16, v170
    v_and_b32 v11, 0xffff0000, v170
    v_mul_f32 v10, v10, v84
    v_mul_f32 v11, v11, v85
    v_cvt_pk_bf16_f32 v12, v10, v11
    v_lshlrev_b32 v10, 16, v12
    v_and_b32 v11, 0xffff0000, v12
    v_add_f32 v8, v8, v10
    v_add_f32 v9, v9, v11
    v_lshlrev_b32 v10, 16, v171
    v_and_b32 v11, 0xffff0000, v171
    v_mul_f32 v10, v10, v86
    v_mul_f32 v11, v11, v87
    v_cvt_pk_bf16_f32 v12, v10, v11
    v_lshlrev_b32 v10, 16, v12
    v_and_b32 v11, 0xffff0000, v12
    v_add_f32 v8, v8, v10
    v_add_f32 v9, v9, v11
    v_lshlrev_b32 v10, 16, v172
    v_and_b32 v11, 0xffff0000, v172
    v_mul_f32 v10, v10, v88
    v_mul_f32 v11, v11, v89
    v_cvt_pk_bf16_f32 v12, v10, v11
    v_lshlrev_b32 v10, 16, v12
    v_and_b32 v11, 0xffff0000, v12
    v_add_f32 v8, v8, v10
    v_add_f32 v9, v9, v11
    v_lshlrev_b32 v10, 16, v173
    v_and_b32 v11, 0xffff0000, v173
    v_mul_f32 v10, v10, v90
    v_mul_f32 v11, v11, v91
    v_cvt_pk_bf16_f32 v12, v10, v11
    v_lshlrev_b32 v10, 16, v12
    v_and_b32 v11, 0xffff0000, v12
    v_add_f32 v8, v8, v10
    v_add_f32 v9, v9, v11
    v_lshlrev_b32 v10, 16, v174
    v_and_b32 v11, 0xffff0000, v174
    v_mul_f32 v10, v10, v92
    v_mul_f32 v11, v11, v93
    v_cvt_pk_bf16_f32 v12, v10, v11
    v_lshlrev_b32 v10, 16, v12
    v_and_b32 v11, 0xffff0000, v12
    v_add_f32 v8, v8, v10
    v_add_f32 v9, v9, v11
    v_lshlrev_b32 v10, 16, v175
    v_and_b32 v11, 0xffff0000, v175
    v_mul_f32 v10, v10, v94
    v_mul_f32 v11, v11, v95
    v_cvt_pk_bf16_f32 v12, v10, v11
    v_lshlrev_b32 v10, 16, v12
    v_and_b32 v11, 0xffff0000, v12
    v_add_f32 v8, v8, v10
    v_add_f32 v9, v9, v11
    v_lshlrev_b32 v10, 16, v176
    v_and_b32 v11, 0xffff0000, v176
    v_mul_f32 v10, v10, v96
    v_mul_f32 v11, v11, v97
    v_cvt_pk_bf16_f32 v12, v10, v11
    v_lshlrev_b32 v10, 16, v12
    v_and_b32 v11, 0xffff0000, v12
    v_add_f32 v8, v8, v10
    v_add_f32 v9, v9, v11
    v_lshlrev_b32 v10, 16, v177
    v_and_b32 v11, 0xffff0000, v177
    v_mul_f32 v10, v10, v98
    v_mul_f32 v11, v11, v99
    v_cvt_pk_bf16_f32 v12, v10, v11
    v_lshlrev_b32 v10, 16, v12
    v_and_b32 v11, 0xffff0000, v12
    v_add_f32 v8, v8, v10
    v_add_f32 v9, v9, v11
    v_lshlrev_b32 v10, 16, v178
    v_and_b32 v11, 0xffff0000, v178
    v_mul_f32 v10, v10, v100
    v_mul_f32 v11, v11, v101
    v_cvt_pk_bf16_f32 v12, v10, v11
    v_lshlrev_b32 v10, 16, v12
    v_and_b32 v11, 0xffff0000, v12
    v_add_f32 v8, v8, v10
    v_add_f32 v9, v9, v11
    v_lshlrev_b32 v10, 16, v179
    v_and_b32 v11, 0xffff0000, v179
    v_mul_f32 v10, v10, v102
    v_mul_f32 v11, v11, v103
    v_cvt_pk_bf16_f32 v12, v10, v11
    v_lshlrev_b32 v10, 16, v12
    v_and_b32 v11, 0xffff0000, v12
    v_add_f32 v8, v8, v10
    v_add_f32 v9, v9, v11
    v_lshlrev_b32 v10, 16, v180
    v_and_b32 v11, 0xffff0000, v180
    v_mul_f32 v10, v10, v104
    v_mul_f32 v11, v11, v105
    v_cvt_pk_bf16_f32 v12, v10, v11
    v_lshlrev_b32 v10, 16, v12
    v_and_b32 v11, 0xffff0000, v12
    v_add_f32 v8, v8, v10
    v_add_f32 v9, v9, v11
    v_lshlrev_b32 v10, 16, v181
    v_and_b32 v11, 0xffff0000, v181
    v_mul_f32 v10, v10, v106
    v_mul_f32 v11, v11, v107
    v_cvt_pk_bf16_f32 v12, v10, v11
    v_lshlrev_b32 v10, 16, v12
    v_and_b32 v11, 0xffff0000, v12
    v_add_f32 v8, v8, v10
    v_add_f32 v9, v9, v11
    v_lshlrev_b32 v10, 16, v182
    v_and_b32 v11, 0xffff0000, v182
    v_mul_f32 v10, v10, v108
    v_mul_f32 v11, v11, v109
    v_cvt_pk_bf16_f32 v12, v10, v11
    v_lshlrev_b32 v10, 16, v12
    v_and_b32 v11, 0xffff0000, v12
    v_add_f32 v8, v8, v10
    v_add_f32 v9, v9, v11
    v_lshlrev_b32 v10, 16, v183
    v_and_b32 v11, 0xffff0000, v183
    v_mul_f32 v10, v10, v110
    v_mul_f32 v11, v11, v111
    v_cvt_pk_bf16_f32 v12, v10, v11
    v_lshlrev_b32 v10, 16, v12
    v_and_b32 v11, 0xffff0000, v12
    v_add_f32 v8, v8, v10
    v_add_f32 v9, v9, v11
    v_lshlrev_b32 v10, 16, v184
    v_and_b32 v11, 0xffff0000, v184
    v_mul_f32 v10, v10, v112
    v_mul_f32 v11, v11, v113
    v_cvt_pk_bf16_f32 v12, v10, v11
    v_lshlrev_b32 v10, 16, v12
    v_and_b32 v11, 0xffff0000, v12
    v_add_f32 v8, v8, v10
    v_add_f32 v9, v9, v11
    v_lshlrev_b32 v10, 16, v185
    v_and_b32 v11, 0xffff0000, v185
    v_mul_f32 v10, v10, v114
    v_mul_f32 v11, v11, v115
    v_cvt_pk_bf16_f32 v12, v10, v11
    v_lshlrev_b32 v10, 16, v12
    v_and_b32 v11, 0xffff0000, v12
    v_add_f32 v8, v8, v10
    v_add_f32 v9, v9, v11
    v_lshlrev_b32 v10, 16, v186
    v_and_b32 v11, 0xffff0000, v186
    v_mul_f32 v10, v10, v116
    v_mul_f32 v11, v11, v117
    v_cvt_pk_bf16_f32 v12, v10, v11
    v_lshlrev_b32 v10, 16, v12
    v_and_b32 v11, 0xffff0000, v12
    v_add_f32 v8, v8, v10
    v_add_f32 v9, v9, v11
    v_lshlrev_b32 v10, 16, v187
    v_and_b32 v11, 0xffff0000, v187
    v_mul_f32 v10, v10, v118
    v_mul_f32 v11, v11, v119
    v_cvt_pk_bf16_f32 v12, v10, v11
    v_lshlrev_b32 v10, 16, v12
    v_and_b32 v11, 0xffff0000, v12
    v_add_f32 v8, v8, v10
    v_add_f32 v9, v9, v11
    v_lshlrev_b32 v10, 16, v188
    v_and_b32 v11, 0xffff0000, v188
    v_mul_f32 v10, v10, v120
    v_mul_f32 v11, v11, v121
    v_cvt_pk_bf16_f32 v12, v10, v11
    v_lshlrev_b32 v10, 16, v12
    v_and_b32 v11, 0xffff0000, v12
    v_add_f32 v8, v8, v10
    v_add_f32 v9, v9, v11
    v_lshlrev_b32 v10, 16, v189
    v_and_b32 v11, 0xffff0000, v189
    v_mul_f32 v10, v10, v122
    v_mul_f32 v11, v11, v123
    v_cvt_pk_bf16_f32 v12, v10, v11
    v_lshlrev_b32 v10, 16, v12
    v_and_b32 v11, 0xffff0000, v12
    v_add_f32 v8, v8, v10
    v_add_f32 v9, v9, v11
    v_lshlrev_b32 v10, 16, v190
    v_and_b32 v11, 0xffff0000, v190
    v_mul_f32 v10, v10, v124
    v_mul_f32 v11, v11, v125
    v_cvt_pk_bf16_f32 v12, v10, v11
    v_lshlrev_b32 v10, 16, v12
    v_and_b32 v11, 0xffff0000, v12
    v_add_f32 v8, v8, v10
    v_add_f32 v9, v9, v11
    v_lshlrev_b32 v10, 16, v191
    v_and_b32 v11, 0xffff0000, v191
    v_mul_f32 v10, v10, v126
    v_mul_f32 v11, v11, v127
    v_cvt_pk_bf16_f32 v12, v10, v11
    v_lshlrev_b32 v10, 16, v12
    v_and_b32 v11, 0xffff0000, v12
    v_add_f32 v8, v8, v10
    v_add_f32 v9, v9, v11
    s_add_u32 s59, s58, 24576
    buffer_load_dwordx4 v[160:163], v5, s[36:39], s59 offen offset:0
    buffer_load_dwordx4 v[164:167], v5, s[36:39], s59 offen offset:16
    buffer_load_dwordx4 v[168:171], v5, s[36:39], s59 offen offset:32
    buffer_load_dwordx4 v[172:175], v5, s[36:39], s59 offen offset:48
    buffer_load_dwordx4 v[176:179], v5, s[36:39], s59 offen offset:64
    buffer_load_dwordx4 v[180:183], v5, s[36:39], s59 offen offset:80
    buffer_load_dwordx4 v[184:187], v5, s[36:39], s59 offen offset:96
    buffer_load_dwordx4 v[188:191], v5, s[36:39], s59 offen offset:112
    v_add_f32 v8, v8, v9
    s_nop 1
    v_add_f32_dpp v8, v8, v8 quad_perm:[1,0,3,2] row_mask:0xf bank_mask:0xf
    s_nop 1
    v_add_f32_dpp v8, v8, v8 quad_perm:[2,3,0,1] row_mask:0xf bank_mask:0xf
    s_nop 1
    v_add_f32_dpp v8, v8, v8 row_half_mirror row_mask:0xf bank_mask:0xf
    s_nop 1
    v_cvt_pk_bf16_f32 v9, v8, v8
    v_lshlrev_b32 v8, 16, v9
    v_mul_f32 v8, s70, v8
    v_exp_f32 v8, v8
    s_nop 0
    v_add_f32 v8, 1.0, v8
    v_rcp_f32 v8, v8
    s_nop 0
    v_cvt_pk_bf16_f32 v9, v8, v8
    v_lshlrev_b32 v13, 16, v9
    buffer_store_dword v13, v6, s[44:47], s60 offen offset:32 sc1
    v_mov_b32 v8, 0
    v_mov_b32 v9, 0
    s_waitcnt vmcnt(8)
    v_lshlrev_b32 v10, 16, v128
    v_and_b32 v11, 0xffff0000, v128
    v_mul_f32 v10, v10, v64
    v_mul_f32 v11, v11, v65
    v_cvt_pk_bf16_f32 v12, v10, v11
    v_lshlrev_b32 v10, 16, v12
    v_and_b32 v11, 0xffff0000, v12
    v_add_f32 v8, v8, v10
    v_add_f32 v9, v9, v11
    v_lshlrev_b32 v10, 16, v129
    v_and_b32 v11, 0xffff0000, v129
    v_mul_f32 v10, v10, v66
    v_mul_f32 v11, v11, v67
    v_cvt_pk_bf16_f32 v12, v10, v11
    v_lshlrev_b32 v10, 16, v12
    v_and_b32 v11, 0xffff0000, v12
    v_add_f32 v8, v8, v10
    v_add_f32 v9, v9, v11
    v_lshlrev_b32 v10, 16, v130
    v_and_b32 v11, 0xffff0000, v130
    v_mul_f32 v10, v10, v68
    v_mul_f32 v11, v11, v69
    v_cvt_pk_bf16_f32 v12, v10, v11
    v_lshlrev_b32 v10, 16, v12
    v_and_b32 v11, 0xffff0000, v12
    v_add_f32 v8, v8, v10
    v_add_f32 v9, v9, v11
    v_lshlrev_b32 v10, 16, v131
    v_and_b32 v11, 0xffff0000, v131
    v_mul_f32 v10, v10, v70
    v_mul_f32 v11, v11, v71
    v_cvt_pk_bf16_f32 v12, v10, v11
    v_lshlrev_b32 v10, 16, v12
    v_and_b32 v11, 0xffff0000, v12
    v_add_f32 v8, v8, v10
    v_add_f32 v9, v9, v11
    v_lshlrev_b32 v10, 16, v132
    v_and_b32 v11, 0xffff0000, v132
    v_mul_f32 v10, v10, v72
    v_mul_f32 v11, v11, v73
    v_cvt_pk_bf16_f32 v12, v10, v11
    v_lshlrev_b32 v10, 16, v12
    v_and_b32 v11, 0xffff0000, v12
    v_add_f32 v8, v8, v10
    v_add_f32 v9, v9, v11
    v_lshlrev_b32 v10, 16, v133
    v_and_b32 v11, 0xffff0000, v133
    v_mul_f32 v10, v10, v74
    v_mul_f32 v11, v11, v75
    v_cvt_pk_bf16_f32 v12, v10, v11
    v_lshlrev_b32 v10, 16, v12
    v_and_b32 v11, 0xffff0000, v12
    v_add_f32 v8, v8, v10
    v_add_f32 v9, v9, v11
    v_lshlrev_b32 v10, 16, v134
    v_and_b32 v11, 0xffff0000, v134
    v_mul_f32 v10, v10, v76
    v_mul_f32 v11, v11, v77
    v_cvt_pk_bf16_f32 v12, v10, v11
    v_lshlrev_b32 v10, 16, v12
    v_and_b32 v11, 0xffff0000, v12
    v_add_f32 v8, v8, v10
    v_add_f32 v9, v9, v11
    v_lshlrev_b32 v10, 16, v135
    v_and_b32 v11, 0xffff0000, v135
    v_mul_f32 v10, v10, v78
    v_mul_f32 v11, v11, v79
    v_cvt_pk_bf16_f32 v12, v10, v11
    v_lshlrev_b32 v10, 16, v12
    v_and_b32 v11, 0xffff0000, v12
    v_add_f32 v8, v8, v10
    v_add_f32 v9, v9, v11
    v_lshlrev_b32 v10, 16, v136
    v_and_b32 v11, 0xffff0000, v136
    v_mul_f32 v10, v10, v80
    v_mul_f32 v11, v11, v81
    v_cvt_pk_bf16_f32 v12, v10, v11
    v_lshlrev_b32 v10, 16, v12
    v_and_b32 v11, 0xffff0000, v12
    v_add_f32 v8, v8, v10
    v_add_f32 v9, v9, v11
    v_lshlrev_b32 v10, 16, v137
    v_and_b32 v11, 0xffff0000, v137
    v_mul_f32 v10, v10, v82
    v_mul_f32 v11, v11, v83
    v_cvt_pk_bf16_f32 v12, v10, v11
    v_lshlrev_b32 v10, 16, v12
    v_and_b32 v11, 0xffff0000, v12
    v_add_f32 v8, v8, v10
    v_add_f32 v9, v9, v11
    v_lshlrev_b32 v10, 16, v138
    v_and_b32 v11, 0xffff0000, v138
    v_mul_f32 v10, v10, v84
    v_mul_f32 v11, v11, v85
    v_cvt_pk_bf16_f32 v12, v10, v11
    v_lshlrev_b32 v10, 16, v12
    v_and_b32 v11, 0xffff0000, v12
    v_add_f32 v8, v8, v10
    v_add_f32 v9, v9, v11
    v_lshlrev_b32 v10, 16, v139
    v_and_b32 v11, 0xffff0000, v139
    v_mul_f32 v10, v10, v86
    v_mul_f32 v11, v11, v87
    v_cvt_pk_bf16_f32 v12, v10, v11
    v_lshlrev_b32 v10, 16, v12
    v_and_b32 v11, 0xffff0000, v12
    v_add_f32 v8, v8, v10
    v_add_f32 v9, v9, v11
    v_lshlrev_b32 v10, 16, v140
    v_and_b32 v11, 0xffff0000, v140
    v_mul_f32 v10, v10, v88
    v_mul_f32 v11, v11, v89
    v_cvt_pk_bf16_f32 v12, v10, v11
    v_lshlrev_b32 v10, 16, v12
    v_and_b32 v11, 0xffff0000, v12
    v_add_f32 v8, v8, v10
    v_add_f32 v9, v9, v11
    v_lshlrev_b32 v10, 16, v141
    v_and_b32 v11, 0xffff0000, v141
    v_mul_f32 v10, v10, v90
    v_mul_f32 v11, v11, v91
    v_cvt_pk_bf16_f32 v12, v10, v11
    v_lshlrev_b32 v10, 16, v12
    v_and_b32 v11, 0xffff0000, v12
    v_add_f32 v8, v8, v10
    v_add_f32 v9, v9, v11
    v_lshlrev_b32 v10, 16, v142
    v_and_b32 v11, 0xffff0000, v142
    v_mul_f32 v10, v10, v92
    v_mul_f32 v11, v11, v93
    v_cvt_pk_bf16_f32 v12, v10, v11
    v_lshlrev_b32 v10, 16, v12
    v_and_b32 v11, 0xffff0000, v12
    v_add_f32 v8, v8, v10
    v_add_f32 v9, v9, v11
    v_lshlrev_b32 v10, 16, v143
    v_and_b32 v11, 0xffff0000, v143
    v_mul_f32 v10, v10, v94
    v_mul_f32 v11, v11, v95
    v_cvt_pk_bf16_f32 v12, v10, v11
    v_lshlrev_b32 v10, 16, v12
    v_and_b32 v11, 0xffff0000, v12
    v_add_f32 v8, v8, v10
    v_add_f32 v9, v9, v11
    v_lshlrev_b32 v10, 16, v144
    v_and_b32 v11, 0xffff0000, v144
    v_mul_f32 v10, v10, v96
    v_mul_f32 v11, v11, v97
    v_cvt_pk_bf16_f32 v12, v10, v11
    v_lshlrev_b32 v10, 16, v12
    v_and_b32 v11, 0xffff0000, v12
    v_add_f32 v8, v8, v10
    v_add_f32 v9, v9, v11
    v_lshlrev_b32 v10, 16, v145
    v_and_b32 v11, 0xffff0000, v145
    v_mul_f32 v10, v10, v98
    v_mul_f32 v11, v11, v99
    v_cvt_pk_bf16_f32 v12, v10, v11
    v_lshlrev_b32 v10, 16, v12
    v_and_b32 v11, 0xffff0000, v12
    v_add_f32 v8, v8, v10
    v_add_f32 v9, v9, v11
    v_lshlrev_b32 v10, 16, v146
    v_and_b32 v11, 0xffff0000, v146
    v_mul_f32 v10, v10, v100
    v_mul_f32 v11, v11, v101
    v_cvt_pk_bf16_f32 v12, v10, v11
    v_lshlrev_b32 v10, 16, v12
    v_and_b32 v11, 0xffff0000, v12
    v_add_f32 v8, v8, v10
    v_add_f32 v9, v9, v11
    v_lshlrev_b32 v10, 16, v147
    v_and_b32 v11, 0xffff0000, v147
    v_mul_f32 v10, v10, v102
    v_mul_f32 v11, v11, v103
    v_cvt_pk_bf16_f32 v12, v10, v11
    v_lshlrev_b32 v10, 16, v12
    v_and_b32 v11, 0xffff0000, v12
    v_add_f32 v8, v8, v10
    v_add_f32 v9, v9, v11
    v_lshlrev_b32 v10, 16, v148
    v_and_b32 v11, 0xffff0000, v148
    v_mul_f32 v10, v10, v104
    v_mul_f32 v11, v11, v105
    v_cvt_pk_bf16_f32 v12, v10, v11
    v_lshlrev_b32 v10, 16, v12
    v_and_b32 v11, 0xffff0000, v12
    v_add_f32 v8, v8, v10
    v_add_f32 v9, v9, v11
    v_lshlrev_b32 v10, 16, v149
    v_and_b32 v11, 0xffff0000, v149
    v_mul_f32 v10, v10, v106
    v_mul_f32 v11, v11, v107
    v_cvt_pk_bf16_f32 v12, v10, v11
    v_lshlrev_b32 v10, 16, v12
    v_and_b32 v11, 0xffff0000, v12
    v_add_f32 v8, v8, v10
    v_add_f32 v9, v9, v11
    v_lshlrev_b32 v10, 16, v150
    v_and_b32 v11, 0xffff0000, v150
    v_mul_f32 v10, v10, v108
    v_mul_f32 v11, v11, v109
    v_cvt_pk_bf16_f32 v12, v10, v11
    v_lshlrev_b32 v10, 16, v12
    v_and_b32 v11, 0xffff0000, v12
    v_add_f32 v8, v8, v10
    v_add_f32 v9, v9, v11
    v_lshlrev_b32 v10, 16, v151
    v_and_b32 v11, 0xffff0000, v151
    v_mul_f32 v10, v10, v110
    v_mul_f32 v11, v11, v111
    v_cvt_pk_bf16_f32 v12, v10, v11
    v_lshlrev_b32 v10, 16, v12
    v_and_b32 v11, 0xffff0000, v12
    v_add_f32 v8, v8, v10
    v_add_f32 v9, v9, v11
    v_lshlrev_b32 v10, 16, v152
    v_and_b32 v11, 0xffff0000, v152
    v_mul_f32 v10, v10, v112
    v_mul_f32 v11, v11, v113
    v_cvt_pk_bf16_f32 v12, v10, v11
    v_lshlrev_b32 v10, 16, v12
    v_and_b32 v11, 0xffff0000, v12
    v_add_f32 v8, v8, v10
    v_add_f32 v9, v9, v11
    v_lshlrev_b32 v10, 16, v153
    v_and_b32 v11, 0xffff0000, v153
    v_mul_f32 v10, v10, v114
    v_mul_f32 v11, v11, v115
    v_cvt_pk_bf16_f32 v12, v10, v11
    v_lshlrev_b32 v10, 16, v12
    v_and_b32 v11, 0xffff0000, v12
    v_add_f32 v8, v8, v10
    v_add_f32 v9, v9, v11
    v_lshlrev_b32 v10, 16, v154
    v_and_b32 v11, 0xffff0000, v154
    v_mul_f32 v10, v10, v116
    v_mul_f32 v11, v11, v117
    v_cvt_pk_bf16_f32 v12, v10, v11
    v_lshlrev_b32 v10, 16, v12
    v_and_b32 v11, 0xffff0000, v12
    v_add_f32 v8, v8, v10
    v_add_f32 v9, v9, v11
    v_lshlrev_b32 v10, 16, v155
    v_and_b32 v11, 0xffff0000, v155
    v_mul_f32 v10, v10, v118
    v_mul_f32 v11, v11, v119
    v_cvt_pk_bf16_f32 v12, v10, v11
    v_lshlrev_b32 v10, 16, v12
    v_and_b32 v11, 0xffff0000, v12
    v_add_f32 v8, v8, v10
    v_add_f32 v9, v9, v11
    v_lshlrev_b32 v10, 16, v156
    v_and_b32 v11, 0xffff0000, v156
    v_mul_f32 v10, v10, v120
    v_mul_f32 v11, v11, v121
    v_cvt_pk_bf16_f32 v12, v10, v11
    v_lshlrev_b32 v10, 16, v12
    v_and_b32 v11, 0xffff0000, v12
    v_add_f32 v8, v8, v10
    v_add_f32 v9, v9, v11
    v_lshlrev_b32 v10, 16, v157
    v_and_b32 v11, 0xffff0000, v157
    v_mul_f32 v10, v10, v122
    v_mul_f32 v11, v11, v123
    v_cvt_pk_bf16_f32 v12, v10, v11
    v_lshlrev_b32 v10, 16, v12
    v_and_b32 v11, 0xffff0000, v12
    v_add_f32 v8, v8, v10
    v_add_f32 v9, v9, v11
    v_lshlrev_b32 v10, 16, v158
    v_and_b32 v11, 0xffff0000, v158
    v_mul_f32 v10, v10, v124
    v_mul_f32 v11, v11, v125
    v_cvt_pk_bf16_f32 v12, v10, v11
    v_lshlrev_b32 v10, 16, v12
    v_and_b32 v11, 0xffff0000, v12
    v_add_f32 v8, v8, v10
    v_add_f32 v9, v9, v11
    v_lshlrev_b32 v10, 16, v159
    v_and_b32 v11, 0xffff0000, v159
    v_mul_f32 v10, v10, v126
    v_mul_f32 v11, v11, v127
    v_cvt_pk_bf16_f32 v12, v10, v11
    v_lshlrev_b32 v10, 16, v12
    v_and_b32 v11, 0xffff0000, v12
    v_add_f32 v8, v8, v10
    v_add_f32 v9, v9, v11
    v_add_f32 v8, v8, v9
    s_nop 1
    v_add_f32_dpp v8, v8, v8 quad_perm:[1,0,3,2] row_mask:0xf bank_mask:0xf
    s_nop 1
    v_add_f32_dpp v8, v8, v8 quad_perm:[2,3,0,1] row_mask:0xf bank_mask:0xf
    s_nop 1
    v_add_f32_dpp v8, v8, v8 row_half_mirror row_mask:0xf bank_mask:0xf
    s_nop 1
    v_cvt_pk_bf16_f32 v9, v8, v8
    v_lshlrev_b32 v8, 16, v9
    v_mul_f32 v8, s70, v8
    v_exp_f32 v8, v8
    s_nop 0
    v_add_f32 v8, 1.0, v8
    v_rcp_f32 v8, v8
    s_nop 0
    v_cvt_pk_bf16_f32 v9, v8, v8
    v_lshlrev_b32 v13, 16, v9
    buffer_store_dword v13, v6, s[44:47], s60 offen offset:64 sc1
    v_mov_b32 v8, 0
    v_mov_b32 v9, 0
    s_waitcnt vmcnt(0)
    v_lshlrev_b32 v10, 16, v160
    v_and_b32 v11, 0xffff0000, v160
    v_mul_f32 v10, v10, v64
    v_mul_f32 v11, v11, v65
    v_cvt_pk_bf16_f32 v12, v10, v11
    v_lshlrev_b32 v10, 16, v12
    v_and_b32 v11, 0xffff0000, v12
    v_add_f32 v8, v8, v10
    v_add_f32 v9, v9, v11
    v_lshlrev_b32 v10, 16, v161
    v_and_b32 v11, 0xffff0000, v161
    v_mul_f32 v10, v10, v66
    v_mul_f32 v11, v11, v67
    v_cvt_pk_bf16_f32 v12, v10, v11
    v_lshlrev_b32 v10, 16, v12
    v_and_b32 v11, 0xffff0000, v12
    v_add_f32 v8, v8, v10
    v_add_f32 v9, v9, v11
    v_lshlrev_b32 v10, 16, v162
    v_and_b32 v11, 0xffff0000, v162
    v_mul_f32 v10, v10, v68
    v_mul_f32 v11, v11, v69
    v_cvt_pk_bf16_f32 v12, v10, v11
    v_lshlrev_b32 v10, 16, v12
    v_and_b32 v11, 0xffff0000, v12
    v_add_f32 v8, v8, v10
    v_add_f32 v9, v9, v11
    v_lshlrev_b32 v10, 16, v163
    v_and_b32 v11, 0xffff0000, v163
    v_mul_f32 v10, v10, v70
    v_mul_f32 v11, v11, v71
    v_cvt_pk_bf16_f32 v12, v10, v11
    v_lshlrev_b32 v10, 16, v12
    v_and_b32 v11, 0xffff0000, v12
    v_add_f32 v8, v8, v10
    v_add_f32 v9, v9, v11
    v_lshlrev_b32 v10, 16, v164
    v_and_b32 v11, 0xffff0000, v164
    v_mul_f32 v10, v10, v72
    v_mul_f32 v11, v11, v73
    v_cvt_pk_bf16_f32 v12, v10, v11
    v_lshlrev_b32 v10, 16, v12
    v_and_b32 v11, 0xffff0000, v12
    v_add_f32 v8, v8, v10
    v_add_f32 v9, v9, v11
    v_lshlrev_b32 v10, 16, v165
    v_and_b32 v11, 0xffff0000, v165
    v_mul_f32 v10, v10, v74
    v_mul_f32 v11, v11, v75
    v_cvt_pk_bf16_f32 v12, v10, v11
    v_lshlrev_b32 v10, 16, v12
    v_and_b32 v11, 0xffff0000, v12
    v_add_f32 v8, v8, v10
    v_add_f32 v9, v9, v11
    v_lshlrev_b32 v10, 16, v166
    v_and_b32 v11, 0xffff0000, v166
    v_mul_f32 v10, v10, v76
    v_mul_f32 v11, v11, v77
    v_cvt_pk_bf16_f32 v12, v10, v11
    v_lshlrev_b32 v10, 16, v12
    v_and_b32 v11, 0xffff0000, v12
    v_add_f32 v8, v8, v10
    v_add_f32 v9, v9, v11
    v_lshlrev_b32 v10, 16, v167
    v_and_b32 v11, 0xffff0000, v167
    v_mul_f32 v10, v10, v78
    v_mul_f32 v11, v11, v79
    v_cvt_pk_bf16_f32 v12, v10, v11
    v_lshlrev_b32 v10, 16, v12
    v_and_b32 v11, 0xffff0000, v12
    v_add_f32 v8, v8, v10
    v_add_f32 v9, v9, v11
    v_lshlrev_b32 v10, 16, v168
    v_and_b32 v11, 0xffff0000, v168
    v_mul_f32 v10, v10, v80
    v_mul_f32 v11, v11, v81
    v_cvt_pk_bf16_f32 v12, v10, v11
    v_lshlrev_b32 v10, 16, v12
    v_and_b32 v11, 0xffff0000, v12
    v_add_f32 v8, v8, v10
    v_add_f32 v9, v9, v11
    v_lshlrev_b32 v10, 16, v169
    v_and_b32 v11, 0xffff0000, v169
    v_mul_f32 v10, v10, v82
    v_mul_f32 v11, v11, v83
    v_cvt_pk_bf16_f32 v12, v10, v11
    v_lshlrev_b32 v10, 16, v12
    v_and_b32 v11, 0xffff0000, v12
    v_add_f32 v8, v8, v10
    v_add_f32 v9, v9, v11
    v_lshlrev_b32 v10, 16, v170
    v_and_b32 v11, 0xffff0000, v170
    v_mul_f32 v10, v10, v84
    v_mul_f32 v11, v11, v85
    v_cvt_pk_bf16_f32 v12, v10, v11
    v_lshlrev_b32 v10, 16, v12
    v_and_b32 v11, 0xffff0000, v12
    v_add_f32 v8, v8, v10
    v_add_f32 v9, v9, v11
    v_lshlrev_b32 v10, 16, v171
    v_and_b32 v11, 0xffff0000, v171
    v_mul_f32 v10, v10, v86
    v_mul_f32 v11, v11, v87
    v_cvt_pk_bf16_f32 v12, v10, v11
    v_lshlrev_b32 v10, 16, v12
    v_and_b32 v11, 0xffff0000, v12
    v_add_f32 v8, v8, v10
    v_add_f32 v9, v9, v11
    v_lshlrev_b32 v10, 16, v172
    v_and_b32 v11, 0xffff0000, v172
    v_mul_f32 v10, v10, v88
    v_mul_f32 v11, v11, v89
    v_cvt_pk_bf16_f32 v12, v10, v11
    v_lshlrev_b32 v10, 16, v12
    v_and_b32 v11, 0xffff0000, v12
    v_add_f32 v8, v8, v10
    v_add_f32 v9, v9, v11
    v_lshlrev_b32 v10, 16, v173
    v_and_b32 v11, 0xffff0000, v173
    v_mul_f32 v10, v10, v90
    v_mul_f32 v11, v11, v91
    v_cvt_pk_bf16_f32 v12, v10, v11
    v_lshlrev_b32 v10, 16, v12
    v_and_b32 v11, 0xffff0000, v12
    v_add_f32 v8, v8, v10
    v_add_f32 v9, v9, v11
    v_lshlrev_b32 v10, 16, v174
    v_and_b32 v11, 0xffff0000, v174
    v_mul_f32 v10, v10, v92
    v_mul_f32 v11, v11, v93
    v_cvt_pk_bf16_f32 v12, v10, v11
    v_lshlrev_b32 v10, 16, v12
    v_and_b32 v11, 0xffff0000, v12
    v_add_f32 v8, v8, v10
    v_add_f32 v9, v9, v11
    v_lshlrev_b32 v10, 16, v175
    v_and_b32 v11, 0xffff0000, v175
    v_mul_f32 v10, v10, v94
    v_mul_f32 v11, v11, v95
    v_cvt_pk_bf16_f32 v12, v10, v11
    v_lshlrev_b32 v10, 16, v12
    v_and_b32 v11, 0xffff0000, v12
    v_add_f32 v8, v8, v10
    v_add_f32 v9, v9, v11
    v_lshlrev_b32 v10, 16, v176
    v_and_b32 v11, 0xffff0000, v176
    v_mul_f32 v10, v10, v96
    v_mul_f32 v11, v11, v97
    v_cvt_pk_bf16_f32 v12, v10, v11
    v_lshlrev_b32 v10, 16, v12
    v_and_b32 v11, 0xffff0000, v12
    v_add_f32 v8, v8, v10
    v_add_f32 v9, v9, v11
    v_lshlrev_b32 v10, 16, v177
    v_and_b32 v11, 0xffff0000, v177
    v_mul_f32 v10, v10, v98
    v_mul_f32 v11, v11, v99
    v_cvt_pk_bf16_f32 v12, v10, v11
    v_lshlrev_b32 v10, 16, v12
    v_and_b32 v11, 0xffff0000, v12
    v_add_f32 v8, v8, v10
    v_add_f32 v9, v9, v11
    v_lshlrev_b32 v10, 16, v178
    v_and_b32 v11, 0xffff0000, v178
    v_mul_f32 v10, v10, v100
    v_mul_f32 v11, v11, v101
    v_cvt_pk_bf16_f32 v12, v10, v11
    v_lshlrev_b32 v10, 16, v12
    v_and_b32 v11, 0xffff0000, v12
    v_add_f32 v8, v8, v10
    v_add_f32 v9, v9, v11
    v_lshlrev_b32 v10, 16, v179
    v_and_b32 v11, 0xffff0000, v179
    v_mul_f32 v10, v10, v102
    v_mul_f32 v11, v11, v103
    v_cvt_pk_bf16_f32 v12, v10, v11
    v_lshlrev_b32 v10, 16, v12
    v_and_b32 v11, 0xffff0000, v12
    v_add_f32 v8, v8, v10
    v_add_f32 v9, v9, v11
    v_lshlrev_b32 v10, 16, v180
    v_and_b32 v11, 0xffff0000, v180
    v_mul_f32 v10, v10, v104
    v_mul_f32 v11, v11, v105
    v_cvt_pk_bf16_f32 v12, v10, v11
    v_lshlrev_b32 v10, 16, v12
    v_and_b32 v11, 0xffff0000, v12
    v_add_f32 v8, v8, v10
    v_add_f32 v9, v9, v11
    v_lshlrev_b32 v10, 16, v181
    v_and_b32 v11, 0xffff0000, v181
    v_mul_f32 v10, v10, v106
    v_mul_f32 v11, v11, v107
    v_cvt_pk_bf16_f32 v12, v10, v11
    v_lshlrev_b32 v10, 16, v12
    v_and_b32 v11, 0xffff0000, v12
    v_add_f32 v8, v8, v10
    v_add_f32 v9, v9, v11
    v_lshlrev_b32 v10, 16, v182
    v_and_b32 v11, 0xffff0000, v182
    v_mul_f32 v10, v10, v108
    v_mul_f32 v11, v11, v109
    v_cvt_pk_bf16_f32 v12, v10, v11
    v_lshlrev_b32 v10, 16, v12
    v_and_b32 v11, 0xffff0000, v12
    v_add_f32 v8, v8, v10
    v_add_f32 v9, v9, v11
    v_lshlrev_b32 v10, 16, v183
    v_and_b32 v11, 0xffff0000, v183
    v_mul_f32 v10, v10, v110
    v_mul_f32 v11, v11, v111
    v_cvt_pk_bf16_f32 v12, v10, v11
    v_lshlrev_b32 v10, 16, v12
    v_and_b32 v11, 0xffff0000, v12
    v_add_f32 v8, v8, v10
    v_add_f32 v9, v9, v11
    v_lshlrev_b32 v10, 16, v184
    v_and_b32 v11, 0xffff0000, v184
    v_mul_f32 v10, v10, v112
    v_mul_f32 v11, v11, v113
    v_cvt_pk_bf16_f32 v12, v10, v11
    v_lshlrev_b32 v10, 16, v12
    v_and_b32 v11, 0xffff0000, v12
    v_add_f32 v8, v8, v10
    v_add_f32 v9, v9, v11
    v_lshlrev_b32 v10, 16, v185
    v_and_b32 v11, 0xffff0000, v185
    v_mul_f32 v10, v10, v114
    v_mul_f32 v11, v11, v115
    v_cvt_pk_bf16_f32 v12, v10, v11
    v_lshlrev_b32 v10, 16, v12
    v_and_b32 v11, 0xffff0000, v12
    v_add_f32 v8, v8, v10
    v_add_f32 v9, v9, v11
    v_lshlrev_b32 v10, 16, v186
    v_and_b32 v11, 0xffff0000, v186
    v_mul_f32 v10, v10, v116
    v_mul_f32 v11, v11, v117
    v_cvt_pk_bf16_f32 v12, v10, v11
    v_lshlrev_b32 v10, 16, v12
    v_and_b32 v11, 0xffff0000, v12
    v_add_f32 v8, v8, v10
    v_add_f32 v9, v9, v11
    v_lshlrev_b32 v10, 16, v187
    v_and_b32 v11, 0xffff0000, v187
    v_mul_f32 v10, v10, v118
    v_mul_f32 v11, v11, v119
    v_cvt_pk_bf16_f32 v12, v10, v11
    v_lshlrev_b32 v10, 16, v12
    v_and_b32 v11, 0xffff0000, v12
    v_add_f32 v8, v8, v10
    v_add_f32 v9, v9, v11
    v_lshlrev_b32 v10, 16, v188
    v_and_b32 v11, 0xffff0000, v188
    v_mul_f32 v10, v10, v120
    v_mul_f32 v11, v11, v121
    v_cvt_pk_bf16_f32 v12, v10, v11
    v_lshlrev_b32 v10, 16, v12
    v_and_b32 v11, 0xffff0000, v12
    v_add_f32 v8, v8, v10
    v_add_f32 v9, v9, v11
    v_lshlrev_b32 v10, 16, v189
    v_and_b32 v11, 0xffff0000, v189
    v_mul_f32 v10, v10, v122
    v_mul_f32 v11, v11, v123
    v_cvt_pk_bf16_f32 v12, v10, v11
    v_lshlrev_b32 v10, 16, v12
    v_and_b32 v11, 0xffff0000, v12
    v_add_f32 v8, v8, v10
    v_add_f32 v9, v9, v11
    v_lshlrev_b32 v10, 16, v190
    v_and_b32 v11, 0xffff0000, v190
    v_mul_f32 v10, v10, v124
    v_mul_f32 v11, v11, v125
    v_cvt_pk_bf16_f32 v12, v10, v11
    v_lshlrev_b32 v10, 16, v12
    v_and_b32 v11, 0xffff0000, v12
    v_add_f32 v8, v8, v10
    v_add_f32 v9, v9, v11
    v_lshlrev_b32 v10, 16, v191
    v_and_b32 v11, 0xffff0000, v191
    v_mul_f32 v10, v10, v126
    v_mul_f32 v11, v11, v127
    v_cvt_pk_bf16_f32 v12, v10, v11
    v_lshlrev_b32 v10, 16, v12
    v_and_b32 v11, 0xffff0000, v12
    v_add_f32 v8, v8, v10
    v_add_f32 v9, v9, v11
    v_add_f32 v8, v8, v9
    s_nop 1
    v_add_f32_dpp v8, v8, v8 quad_perm:[1,0,3,2] row_mask:0xf bank_mask:0xf
    s_nop 1
    v_add_f32_dpp v8, v8, v8 quad_perm:[2,3,0,1] row_mask:0xf bank_mask:0xf
    s_nop 1
    v_add_f32_dpp v8, v8, v8 row_half_mirror row_mask:0xf bank_mask:0xf
    s_nop 1
    v_cvt_pk_bf16_f32 v9, v8, v8
    v_lshlrev_b32 v8, 16, v9
    v_mul_f32 v8, s70, v8
    v_exp_f32 v8, v8
    s_nop 0
    v_add_f32 v8, 1.0, v8
    v_rcp_f32 v8, v8
    s_nop 0
    v_cvt_pk_bf16_f32 v9, v8, v8
    v_lshlrev_b32 v13, 16, v9
    buffer_store_dword v13, v6, s[44:47], s60 offen offset:96 sc1
K1_END:
    s_endpgm
.globl k2_kernel
.p2align 8
.type k2_kernel,@function
k2_kernel:
    s_cmp_ge_u32 s2, 256
    s_cbranch_scc1 K2_END
    s_load_dwordx2 s[32:33], s[0:1], 80
    s_load_dwordx2 s[28:29], s[0:1], 48
    s_load_dwordx2 s[34:35], s[0:1], 16
    s_load_dwordx4 s[36:39], s[0:1], 64
    v_lshrrev_b32 v2, 6, v0
    v_and_b32 v1, 63, v0
    s_nop 0
    v_readfirstlane_b32 s3, v2
    s_and_b32 s4, s2, 7
    s_lshl_b32 s4, s4, 2
    s_bfe_u32 s5, s2, 0x20003
    s_add_u32 s4, s4, s5
    s_lshr_b32 s5, s2, 5
    s_waitcnt lgkmcnt(0)
    s_mov_b32 s44, s32
    s_and_b32 s45, s33, 0xffff
    s_mov_b32 s46, 41943040
    s_mov_b32 s47, 0x20000
    v_lshlrev_b32 v2, 4, v1
    v_mov_b32 v3, 0x23000
    v_mov_b32 v4, 0
    v_mov_b32 v5, 0
    ds_write_b64 v3, v[4:5]
    ds_write_b64 v3, v[4:5] offset:8
    ds_write_b64 v3, v[4:5] offset:16
    s_lshl_b32 s26, s5, 2
    s_lshr_b32 s27, s4, 3
    s_add_u32 s26, s26, s27
    s_and_b32 s27, s4, 7
    s_waitcnt lgkmcnt(0)
    s_barrier
    s_cmp_ge_u32 s3, 8
    s_cbranch_scc1 K2_FFN
    s_lshl_b32 s6, s4, 16
    s_lshl_b32 s7, s3, 13
    s_add_u32 s8, s6, s7
    s_add_u32 s9, s8, 6291456
    s_add_u32 s10, s8, 8388608
    s_lshl_b32 s12, s5, 3
    s_add_u32 s12, s12, s3
    s_lshl_b32 s13, s12, 10
    s_add_u32 s13, s13, s6
    buffer_load_dwordx4 v[8:11], v2, s[44:47], s13 offen
    s_lshl_b32 s14, s4, 8
    s_add_u32 s14, s14, 18939904
    v_lshlrev_b32 v3, 2, v1
    buffer_load_dword v12, v3, s[44:47], s14 offen
    s_lshl_b32 s7, s3, 11
    s_add_u32 s9, s6, s7
    s_add_u32 s10, s9, 8388608
    s_add_u32 s9, s9, 6291456
    s_add_u32 m0, s7, 0
    s_add_u32 s11, s9, 0
    buffer_load_dwordx4 v2, s[44:47], s11 offen lds
    s_add_u32 m0, s7, 65536
    s_add_u32 s11, s10, 0
    buffer_load_dwordx4 v2, s[44:47], s11 offen lds
    s_add_u32 m0, s7, 1024
    s_add_u32 s11, s9, 1024
    buffer_load_dwordx4 v2, s[44:47], s11 offen lds
    s_add_u32 m0, s7, 66560
    s_add_u32 s11, s10, 1024
    buffer_load_dwordx4 v2, s[44:47], s11 offen lds
    s_mul_i32 s7, s3, 6144
    s_add_u32 s7, s7, 16384
    s_add_u32 s9, s6, s7
    s_add_u32 s10, s9, 8388608
    s_add_u32 s9, s9, 6291456
    s_add_u32 m0, s7, 0
    s_add_u32 s11, s9, 0
    buffer_load_dwordx4 v2, s[44:47], s11 offen lds
    s_add_u32 m0, s7, 65536
    s_add_u32 s11, s10, 0
    buffer_load_dwordx4 v2, s[44:47], s11 offen lds
    s_add_u32 m0, s7, 1024
    s_add_u32 s11, s9, 1024
    buffer_load_dwordx4 v2, s[44:47], s11 offen lds
    s_add_u32 m0, s7, 66560
    s_add_u32 s11, s10, 1024
    buffer_load_dwordx4 v2, s[44:47], s11 offen lds
    s_add_u32 m0, s7, 2048
    s_add_u32 s11, s9, 2048
    buffer_load_dwordx4 v2, s[44:47], s11 offen lds
    s_add_u32 m0, s7, 67584
    s_add_u32 s11, s10, 2048
    buffer_load_dwordx4 v2, s[44:47], s11 offen lds
    s_add_u32 m0, s7, 3072
    s_add_u32 s11, s9, 3072
    buffer_load_dwordx4 v2, s[44:47], s11 offen lds
    s_add_u32 m0, s7, 68608
    s_add_u32 s11, s10, 3072
    buffer_load_dwordx4 v2, s[44:47], s11 offen lds
    s_add_u32 m0, s7, 4096
    s_add_u32 s11, s9, 4096
    buffer_load_dwordx4 v2, s[44:47], s11 offen lds
    s_add_u32 m0, s7, 69632
    s_add_u32 s11, s10, 4096
    buffer_load_dwordx4 v2, s[44:47], s11 offen lds
    s_add_u32 m0, s7, 5120
    s_add_u32 s11, s9, 5120
    buffer_load_dwordx4 v2, s[44:47], s11 offen lds
    s_add_u32 m0, s7, 70656
    s_add_u32 s11, s10, 5120
    buffer_load_dwordx4 v2, s[44:47], s11 offen lds
    v_and_b32 v3, 31, v1
    v_lshrrev_b32 v4, 5, v1
    v_and_b32 v5, 15, v1
    v_lshlrev_b32 v5, 4, v5
    v_lshl_add_u32 v5, v4, 8, v5
    v_add_u32 v13, 0x10000, v5
    v_and_b32 v4, 0x1b, v3
    v_mov_b32 v5, 0x3f803f80
    v_cmp_eq_u32 vcc, 16, v4
    s_nop 1
    v_cndmask_b32 v5, 0, v5, vcc
    s_mov_b32 s30, 0x0000ffff
    s_mov_b32 s31, 0x0000ffff
    s_mov_b32 s23, 0
    s_mov_b32 s25, 0x07060302
    v_mov_b32 v36, v5
    v_mov_b32 v37, v5
    v_mov_b32 v38, v5
    v_mov_b32 v39, v5
    v_mov_b32 v40, v5
    v_mov_b32 v41, v5
    v_mov_b32 v42, v5
    v_mov_b32 v43, v5
    v_mov_b32 v44, v5
    v_mov_b32 v45, v5
    v_mov_b32 v46, v5
    v_mov_b32 v47, v5
    v_mov_b32 v48, v5
    v_mov_b32 v49, v5
    v_mov_b32 v50, v5
    v_mov_b32 v51, v5
    s_waitcnt vmcnt(16)
    v_lshlrev_b32 v14, 16, v8
    v_and_b32 v15, 0xffff0000, v8
    v_mul_f32 v16, v14, v14
    v_fmac_f32 v16, v15, v15
    v_lshlrev_b32 v14, 16, v9
    v_and_b32 v15, 0xffff0000, v9
    v_fmac_f32 v16, v14, v14
    v_fmac_f32 v16, v15, v15
    v_lshlrev_b32 v14, 16, v10
    v_and_b32 v15, 0xffff0000, v10
    v_fmac_f32 v16, v14, v14
    v_fmac_f32 v16, v15, v15
    v_lshlrev_b32 v14, 16, v11
    v_and_b32 v15, 0xffff0000, v11
    v_fmac_f32 v16, v14, v14
    v_fmac_f32 v16, v15, v15
    v_mov_b32 v14, v16
    s_nop 1
    v_permlane32_swap_b32 v16, v14
    s_nop 1
    v_add_f32 v16, v16, v14
    v_max_f32_dpp v12, v12, v12 quad_perm:[1,0,3,2] row_mask:0xf bank_mask:0xf
    s_nop 1
    v_max_f32_dpp v12, v12, v12 quad_perm:[2,3,0,1] row_mask:0xf bank_mask:0xf
    s_nop 1
    v_max_f32_dpp v12, v12, v12 row_half_mirror row_mask:0xf bank_mask:0xf
    s_nop 1
    v_max_f32_dpp v12, v12, v12 row_mirror row_mask:0xf bank_mask:0xf
    s_nop 1
    v_mov_b32 v14, v12
    s_nop 1
    v_permlane16_swap_b32 v12, v14
    s_nop 1
    v_max_f32 v12, v12, v14
    s_nop 1
    v_mov_b32 v14, v12
    s_nop 1
    v_permlane32_swap_b32 v12, v14
    s_nop 1
    v_max_f32 v12, v12, v14
    v_mul_f32 v16, v16, v12
    v_sqrt_f32 v16, v16
    s_nop 0
    v_mul_f32 v132, 0xbf810000, v16
    s_waitcnt vmcnt(12)
    v_mov_b32 v134, 0x23000
    v_mov_b32 v135, 1
    s_mov_b64 exec, 1
    ds_add_u32 v134, v135 offset:0
    s_mov_b64 exec, -1
SY_2001:
    ds_read_b32 v135, v134 offset:0
    s_waitcnt lgkmcnt(0)
    v_readfirstlane_b32 s21, v135
    s_cmp_lt_u32 s21, 8
    s_cbranch_scc1 SY_2001
K2_P2START:
    v_mov_b32 v68, v132
    v_mov_b32 v52, 0
    v_mov_b32 v116, 0
    v_mov_b32 v69, v132
    v_mov_b32 v53, 0
    v_mov_b32 v117, 0
    v_mov_b32 v70, v132
    v_mov_b32 v54, 0
    v_mov_b32 v118, 0
    v_mov_b32 v71, v132
    v_mov_b32 v55, 0
    v_mov_b32 v119, 0
    v_mov_b32 v72, v132
    v_mov_b32 v56, 0
    v_mov_b32 v120, 0
    v_mov_b32 v73, v132
    v_mov_b32 v57, 0
    v_mov_b32 v121, 0
    v_mov_b32 v74, v132
    v_mov_b32 v58, 0
    v_mov_b32 v122, 0
    v_mov_b32 v75, v132
    v_mov_b32 v59, 0
    v_mov_b32 v123, 0
    v_mov_b32 v76, v132
    v_mov_b32 v60, 0
    v_mov_b32 v124, 0
    v_mov_b32 v77, v132
    v_mov_b32 v61, 0
    v_mov_b32 v125, 0
    v_mov_b32 v78, v132
    v_mov_b32 v62, 0
    v_mov_b32 v126, 0
    v_mov_b32 v79, v132
    v_mov_b32 v63, 0
    v_mov_b32 v127, 0
    v_mov_b32 v80, v132
    v_mov_b32 v64, 0
    v_mov_b32 v128, 0
    v_mov_b32 v81, v132
    v_mov_b32 v65, 0
    v_mov_b32 v129, 0
    v_mov_b32 v82, v132
    v_mov_b32 v66, 0
    v_mov_b32 v130, 0
    v_mov_b32 v83, v132
    v_mov_b32 v67, 0
    v_mov_b32 v131, 0
    v_mov_b32 v6, v2
    v_mov_b32 v7, v13
    ds_read_b128 v[20:23], v6
    ds_read_b128 v[24:27], v6 offset:1024
    s_waitcnt lgkmcnt(1)
    v_mfma_f32_32x32x16_bf16 v[84:99], v[20:23], v[8:11], v[68:83]
    s_nop 7
    s_nop 3
    s_mov_b32 s20, 0
K2_P2:
    s_cmp_eq_u32 s20, 3
    s_cbranch_scc0 K2_NOSYNC
    s_cmp_eq_u32 s23, 0
    s_cbranch_scc0 K2_NOSYNC
    s_waitcnt vmcnt(0)
    v_mov_b32 v134, 0x23000
    v_mov_b32 v135, 1
    s_mov_b64 exec, 1
    ds_add_u32 v134, v135 offset:4
    s_mov_b64 exec, -1
SY_2002:
    ds_read_b32 v135, v134 offset:4
    s_waitcnt lgkmcnt(0)
    v_readfirstlane_b32 s21, v135
    s_cmp_lt_u32 s21, 8
    s_cbranch_scc1 SY_2002
K2_NOSYNC:
    ds_read_b128 v[28:31], v6 offset:2048
    s_mov_b64 exec, s[30:31]
    ds_read_b128 v[36:39], v7 offset:0
    ds_read_b128 v[40:43], v7 offset:512
    s_mov_b64 exec, -1
    s_waitcnt lgkmcnt(3)
    v_mfma_f32_32x32x16_bf16 v[100:115], v[24:27], v[8:11], v[68:83]
    v_exp_f32 v84, v84
    v_exp_f32 v85, v85
    v_exp_f32 v86, v86
    v_exp_f32 v87, v87
    v_exp_f32 v88, v88
    v_mfma_f32_32x32x16_bf16 v[116:131], v[44:47], v[60:63], v[116:131]
    v_exp_f32 v89, v89
    v_exp_f32 v90, v90
    v_exp_f32 v91, v91
    v_exp_f32 v92, v92
    v_exp_f32 v93, v93
    v_mfma_f32_32x32x16_bf16 v[116:131], v[48:51], v[64:67], v[116:131]
    v_exp_f32 v94, v94
    v_exp_f32 v95, v95
    v_exp_f32 v96, v96
    v_exp_f32 v97, v97
    v_exp_f32 v98, v98
    v_exp_f32 v99, v99
    v_cvt_pk_bf16_f32 v52, v84, v85
    v_cvt_pk_bf16_f32 v53, v86, v87
    v_cvt_pk_bf16_f32 v54, v88, v89
    v_cvt_pk_bf16_f32 v55, v90, v91
    v_cvt_pk_bf16_f32 v56, v92, v93
    v_cvt_pk_bf16_f32 v57, v94, v95
    v_cvt_pk_bf16_f32 v58, v96, v97
    v_cvt_pk_bf16_f32 v59, v98, v99
    ds_read_b128 v[32:35], v6 offset:3072
    s_mov_b64 exec, s[30:31]
    ds_read_b128 v[44:47], v7 offset:1024
    ds_read_b128 v[48:51], v7 offset:1536
    s_mov_b64 exec, -1
    s_waitcnt lgkmcnt(3)
    v_mfma_f32_32x32x16_bf16 v[84:99], v[28:31], v[8:11], v[68:83]
    v_exp_f32 v100, v100
    v_exp_f32 v101, v101
    v_exp_f32 v102, v102
    v_exp_f32 v103, v103
    v_exp_f32 v104, v104
    v_mfma_f32_32x32x16_bf16 v[116:131], v[36:39], v[52:55], v[116:131]
    v_exp_f32 v105, v105
    v_exp_f32 v106, v106
    v_exp_f32 v107, v107
    v_exp_f32 v108, v108
    v_exp_f32 v109, v109
    v_mfma_f32_32x32x16_bf16 v[116:131], v[40:43], v[56:59], v[116:131]
    v_exp_f32 v110, v110
    v_exp_f32 v111, v111
    v_exp_f32 v112, v112
    v_exp_f32 v113, v113
    v_exp_f32 v114, v114
    v_exp_f32 v115, v115
    v_cvt_pk_bf16_f32 v60, v100, v101
    v_cvt_pk_bf16_f32 v61, v102, v103
    v_cvt_pk_bf16_f32 v62, v104, v105
    v_cvt_pk_bf16_f32 v63, v106, v107
    v_cvt_pk_bf16_f32 v64, v108, v109
    v_cvt_pk_bf16_f32 v65, v110, v111
    v_cvt_pk_bf16_f32 v66, v112, v113
    v_cvt_pk_bf16_f32 v67, v114, v115
    ds_read_b128 v[20:23], v6 offset:4096
    s_mov_b64 exec, s[30:31]
    ds_read_b128 v[36:39], v7 offset:2048
    ds_read_b128 v[40:43], v7 offset:2560
    s_mov_b64 exec, -1
    s_waitcnt lgkmcnt(3)
    v_mfma_f32_32x32x16_bf16 v[100:115], v[32:35], v[8:11], v[68:83]
    v_exp_f32 v84, v84
    v_exp_f32 v85, v85
    v_exp_f32 v86, v86
    v_exp_f32 v87, v87
    v_exp_f32 v88, v88
    v_mfma_f32_32x32x16_bf16 v[116:131], v[44:47], v[60:63], v[116:131]
    v_exp_f32 v89, v89
    v_exp_f32 v90, v90
    v_exp_f32 v91, v91
    v_exp_f32 v92, v92
    v_exp_f32 v93, v93
    v_mfma_f32_32x32x16_bf16 v[116:131], v[48:51], v[64:67], v[116:131]
    v_exp_f32 v94, v94
    v_exp_f32 v95, v95
    v_exp_f32 v96, v96
    v_exp_f32 v97, v97
    v_exp_f32 v98, v98
    v_exp_f32 v99, v99
    v_cvt_pk_bf16_f32 v52, v84, v85
    v_cvt_pk_bf16_f32 v53, v86, v87
    v_cvt_pk_bf16_f32 v54, v88, v89
    v_cvt_pk_bf16_f32 v55, v90, v91
    v_cvt_pk_bf16_f32 v56, v92, v93
    v_cvt_pk_bf16_f32 v57, v94, v95
    v_cvt_pk_bf16_f32 v58, v96, v97
    v_cvt_pk_bf16_f32 v59, v98, v99
    ds_read_b128 v[24:27], v6 offset:5120
    s_mov_b64 exec, s[30:31]
    ds_read_b128 v[44:47], v7 offset:3072
    ds_read_b128 v[48:51], v7 offset:3584
    s_mov_b64 exec, -1
    s_waitcnt lgkmcnt(3)
    v_mfma_f32_32x32x16_bf16 v[84:99], v[20:23], v[8:11], v[68:83]
    v_exp_f32 v100, v100
    v_exp_f32 v101, v101
    v_exp_f32 v102, v102
    v_exp_f32 v103, v103
    v_exp_f32 v104, v104
    v_mfma_f32_32x32x16_bf16 v[116:131], v[36:39], v[52:55], v[116:131]
    v_exp_f32 v105, v105
    v_exp_f32 v106, v106
    v_exp_f32 v107, v107
    v_exp_f32 v108, v108
    v_exp_f32 v109, v109
    v_mfma_f32_32x32x16_bf16 v[116:131], v[40:43], v[56:59], v[116:131]
    v_exp_f32 v110, v110
    v_exp_f32 v111, v111
    v_exp_f32 v112, v112
    v_exp_f32 v113, v113
    v_exp_f32 v114, v114
    v_exp_f32 v115, v115
    v_cvt_pk_bf16_f32 v60, v100, v101
    v_cvt_pk_bf16_f32 v61, v102, v103
    v_cvt_pk_bf16_f32 v62, v104, v105
    v_cvt_pk_bf16_f32 v63, v106, v107
    v_cvt_pk_bf16_f32 v64, v108, v109
    v_cvt_pk_bf16_f32 v65, v110, v111
    v_cvt_pk_bf16_f32 v66, v112, v113
    v_cvt_pk_bf16_f32 v67, v114, v115
    v_add_u32 v6, 0x1000, v6
    v_add_u32 v7, 0x1000, v7
    s_add_u32 s20, s20, 1
    s_cmp_lt_u32 s20, 16
    s_cbranch_scc1 K2_P2
    s_waitcnt lgkmcnt(0)
    s_nop 1
    v_mfma_f32_32x32x16_bf16 v[116:131], v[44:47], v[60:63], v[116:131]
    v_mfma_f32_32x32x16_bf16 v[116:131], v[48:51], v[64:67], v[116:131]
    s_nop 15
    s_nop 3
    s_mov_b32 s24, 0x27000000
    v_cmp_nle_f32 vcc, s24, v124
    s_cmp_eq_u32 s23, 0
    s_cbranch_scc0 K2_FIN
    s_cbranch_vccz K2_FIN
    s_mov_b32 s23, 1
    v_mov_b32 v132, 0xff800000
    v_mov_b32 v133, 0xff800000
    v_mov_b32 v6, v2
    ds_read_b128 v[20:23], v6
    ds_read_b128 v[24:27], v6 offset:1024
    s_waitcnt lgkmcnt(1)
    v_mfma_f32_32x32x16_bf16 v[84:99], v[20:23], v[8:11], 0
    s_nop 7
    s_mov_b32 s20, 0
K2_P1:
    ds_read_b128 v[28:31], v6 offset:2048
    s_waitcnt lgkmcnt(1)
    v_mfma_f32_32x32x16_bf16 v[100:115], v[24:27], v[8:11], 0
    s_nop 1
    v_max3_f32 v132, v132, v84, v85
    v_max3_f32 v133, v133, v86, v87
    v_max3_f32 v132, v132, v88, v89
    v_max3_f32 v133, v133, v90, v91
    v_max3_f32 v132, v132, v92, v93
    v_max3_f32 v133, v133, v94, v95
    v_max3_f32 v132, v132, v96, v97
    v_max3_f32 v133, v133, v98, v99
    ds_read_b128 v[32:35], v6 offset:3072
    s_waitcnt lgkmcnt(1)
    v_mfma_f32_32x32x16_bf16 v[84:99], v[28:31], v[8:11], 0
    s_nop 1
    v_max3_f32 v132, v132, v100, v101
    v_max3_f32 v133, v133, v102, v103
    v_max3_f32 v132, v132, v104, v105
    v_max3_f32 v133, v133, v106, v107
    v_max3_f32 v132, v132, v108, v109
    v_max3_f32 v133, v133, v110, v111
    v_max3_f32 v132, v132, v112, v113
    v_max3_f32 v133, v133, v114, v115
    ds_read_b128 v[20:23], v6 offset:4096
    s_waitcnt lgkmcnt(1)
    v_mfma_f32_32x32x16_bf16 v[100:115], v[32:35], v[8:11], 0
    s_nop 1
    v_max3_f32 v132, v132, v84, v85
    v_max3_f32 v133, v133, v86, v87
    v_max3_f32 v132, v132, v88, v89
    v_max3_f32 v133, v133, v90, v91
    v_max3_f32 v132, v132, v92, v93
    v_max3_f32 v133, v133, v94, v95
    v_max3_f32 v132, v132, v96, v97
    v_max3_f32 v133, v133, v98, v99
    ds_read_b128 v[24:27], v6 offset:5120
    s_waitcnt lgkmcnt(1)
    v_mfma_f32_32x32x16_bf16 v[84:99], v[20:23], v[8:11], 0
    s_nop 1
    v_max3_f32 v132, v132, v100, v101
    v_max3_f32 v133, v133, v102, v103
    v_max3_f32 v132, v132, v104, v105
    v_max3_f32 v133, v133, v106, v107
    v_max3_f32 v132, v132, v108, v109
    v_max3_f32 v133, v133, v110, v111
    v_max3_f32 v132, v132, v112, v113
    v_max3_f32 v133, v133, v114, v115
    v_add_u32 v6, 0x1000, v6
    s_add_u32 s20, s20, 1
    s_cmp_lt_u32 s20, 16
    s_cbranch_scc1 K2_P1
    v_max_f32 v132, v132, v133
    s_nop 1
    v_mov_b32 v133, v132
    s_nop 1
    v_permlane32_swap_b32 v132, v133
    s_nop 1
    v_max_f32 v132, v132, v133
    v_sub_f32 v132, 0, v132
    s_waitcnt lgkmcnt(0)
    s_nop 7
    s_nop 7
    s_branch K2_P2START
K2_FIN:
    v_rcp_f32 v132, v124
    s_nop 0
    v_mul_f32 v116, v116, v132
    v_mul_f32 v117, v117, v132
    v_mul_f32 v118, v118, v132
    v_mul_f32 v119, v119, v132
    v_mul_f32 v120, v120, v132
    v_mul_f32 v121, v121, v132
    v_mul_f32 v122, v122, v132
    v_mul_f32 v123, v123, v132
    v_cvt_pk_bf16_f32 v52, v116, v117
    v_cvt_pk_bf16_f32 v53, v118, v119
    v_cvt_pk_bf16_f32 v54, v120, v121
    v_cvt_pk_bf16_f32 v55, v122, v123
    s_lshl_b32 s13, s12, 5
    s_add_u32 s13, s13, s4
    s_lshl_b32 s13, s13, 10
    s_add_u32 s13, s13, 16777216
    buffer_store_dwordx4 v[52:55], v2, s[44:47], s13 offen sc1
    s_mov_b32 s48, s34
    s_and_b32 s49, s35, 0xffff
    s_mov_b32 s50, 524288
    s_mov_b32 s51, 0x20000
    s_mov_b32 s52, s38
    s_and_b32 s53, s39, 0xffff
    s_mov_b32 s54, 256
    s_mov_b32 s55, 0x20000
    s_mov_b32 s56, s36
    s_and_b32 s57, s37, 0xffff
    s_mov_b32 s58, 2097152
    s_mov_b32 s59, 0x20000
    s_waitcnt vmcnt(0)
    v_mov_b32 v134, 0x23000
    v_mov_b32 v135, 1
    s_mov_b64 exec, 1
    ds_add_u32 v134, v135 offset:8
    s_mov_b64 exec, -1
SY_2003:
    ds_read_b32 v135, v134 offset:8
    s_waitcnt lgkmcnt(0)
    v_readfirstlane_b32 s21, v135
    s_cmp_lt_u32 s21, 8
    s_cbranch_scc1 SY_2003
    s_lshl_b32 s60, s5, 5
    v_mov_b32 v10, s60
    v_mov_b32 v11, 1
    s_cmp_eq_u32 s3, 0
    s_cbranch_scc0 K2T_NOARR
    s_mov_b64 exec, 1
    buffer_atomic_add v11, v10, s[52:55], 0 offen sc1
    s_mov_b64 exec, -1
K2T_NOARR:
    v_lshrrev_b32 v4, 3, v1
    v_lshlrev_b32 v4, 10, v4
    v_bfe_u32 v5, v1, 4, 1
    v_lshlrev_b32 v5, 2, v5
    v_and_b32 v6, 7, v1
    v_xor_b32 v5, v5, v6
    v_lshl_add_u32 v4, v5, 4, v4
    s_lshl_b32 s9, s27, 7
    v_add_u32 v8, s9, v4
    s_lshl_b32 s14, s3, 16
    s_lshl_b32 s15, s3, 13
    s_add_u32 m0, s15, 0
    s_add_u32 s16, s14, 0
    buffer_load_dwordx4 v8, s[48:51], s16 offen lds
    s_add_u32 m0, s15, 1024
    s_add_u32 s16, s14, 8192
    buffer_load_dwordx4 v8, s[48:51], s16 offen lds
    s_add_u32 m0, s15, 2048
    s_add_u32 s16, s14, 16384
    buffer_load_dwordx4 v8, s[48:51], s16 offen lds
    s_add_u32 m0, s15, 3072
    s_add_u32 s16, s14, 24576
    buffer_load_dwordx4 v8, s[48:51], s16 offen lds
    s_add_u32 m0, s15, 4096
    s_add_u32 s16, s14, 32768
    buffer_load_dwordx4 v8, s[48:51], s16 offen lds
    s_add_u32 m0, s15, 5120
    s_add_u32 s16, s14, 40960
    buffer_load_dwordx4 v8, s[48:51], s16 offen lds
    s_add_u32 m0, s15, 6144
    s_add_u32 s16, s14, 49152
    buffer_load_dwordx4 v8, s[48:51], s16 offen lds
    s_add_u32 m0, s15, 7168
    s_add_u32 s16, s14, 57344
    buffer_load_dwordx4 v8, s[48:51], s16 offen lds
    s_and_b32 s61, s3, 1
    s_bfe_u32 s62, s3, 0x10001
    v_mov_b32 v134, 0x23000
    v_mov_b32 v135, 1
    s_waitcnt vmcnt(0)
    s_mov_b64 exec, 1
    ds_add_u32 v134, v135 offset:12
    s_mov_b64 exec, -1
    s_cmp_ge_u32 s3, 4
    s_cbranch_scc1 K2_END
    v_bfe_u32 v5, v1, 2, 2
    v_lshrrev_b32 v6, 5, v1
    v_lshl_add_u32 v6, v6, 2, v5
    v_lshlrev_b32 v6, 7, v6
    v_bfe_u32 v7, v1, 0, 1
    v_lshl_add_u32 v6, v7, 5, v6
    v_bfe_u32 v7, v1, 4, 1
    v_lshl_add_u32 v6, v7, 4, v6
    v_bfe_u32 v7, v1, 1, 1
    v_lshl_add_u32 v6, v7, 3, v6
    v_bfe_u32 v7, v1, 3, 1
    v_xor_b32 v7, s62, v7
    v_lshl_add_u32 v3, v7, 6, v6
    s_lshl_b32 s63, s26, 6
    s_lshl_b32 s64, s61, 5
    s_add_u32 s63, s63, s64
    v_and_b32 v7, 31, v1
    v_add_u32 v7, s63, v7
    v_lshlrev_b32 v9, 2, v7
    s_mov_b32 s64, 18874368
    buffer_load_dword v12, v9, s[44:47], s64 offen
    v_mov_b32 v100, 0
    v_mov_b32 v101, 0
    v_mov_b32 v102, 0
    v_mov_b32 v103, 0
    v_mov_b32 v104, 0
    v_mov_b32 v105, 0
    v_mov_b32 v106, 0
    v_mov_b32 v107, 0
    v_mov_b32 v108, 0
    v_mov_b32 v109, 0
    v_mov_b32 v110, 0
    v_mov_b32 v111, 0
    v_mov_b32 v112, 0
    v_mov_b32 v113, 0
    v_mov_b32 v114, 0
    v_mov_b32 v115, 0
    s_lshl_b32 s16, s26, 1
    s_add_u32 s16, s16, s61
    s_lshl_b32 s16, s16, 15
    s_add_u32 s16, s16, 16777216
    s_cmp_eq_u32 s3, 0
    s_cbranch_scc0 K2T_WAITL
K2T_POLL:
    buffer_load_dword v11, v10, s[52:55], 0 offen sc1
    s_waitcnt vmcnt(0)
    v_readfirstlane_b32 s21, v11
    s_cmp_ge_u32 s21, 32
    s_cbranch_scc1 K2T_GO
    s_sleep 1
    s_branch K2T_POLL
K2T_GO:
    v_mov_b32 v135, 1
    ds_write_b32 v134, v135 offset:16
    s_branch K2T_RDY
K2T_WAITL:
    ds_read_b32 v135, v134 offset:16
    s_waitcnt lgkmcnt(0)
    v_readfirstlane_b32 s21, v135
    s_cmp_eq_u32 s21, 0
    s_cbranch_scc0 K2T_RDY
    s_sleep 1
    s_branch K2T_WAITL
K2T_RDY:
    s_add_u32 s17, s16, 0
    buffer_load_dwordx4 v[20:23], v2, s[44:47], s17 offen offset:0 sc1
    buffer_load_dwordx4 v[24:27], v2, s[44:47], s17 offen offset:1024 sc1
    buffer_load_dwordx4 v[28:31], v2, s[44:47], s17 offen offset:2048 sc1
    buffer_load_dwordx4 v[32:35], v2, s[44:47], s17 offen offset:3072 sc1
    s_add_u32 s17, s16, 4096
    buffer_load_dwordx4 v[36:39], v2, s[44:47], s17 offen offset:0 sc1
    buffer_load_dwordx4 v[40:43], v2, s[44:47], s17 offen offset:1024 sc1
    buffer_load_dwordx4 v[44:47], v2, s[44:47], s17 offen offset:2048 sc1
    buffer_load_dwordx4 v[48:51], v2, s[44:47], s17 offen offset:3072 sc1
    s_add_u32 s17, s16, 8192
    buffer_load_dwordx4 v[52:55], v2, s[44:47], s17 offen offset:0 sc1
    buffer_load_dwordx4 v[56:59], v2, s[44:47], s17 offen offset:1024 sc1
    buffer_load_dwordx4 v[60:63], v2, s[44:47], s17 offen offset:2048 sc1
    buffer_load_dwordx4 v[64:67], v2, s[44:47], s17 offen offset:3072 sc1
    s_add_u32 s17, s16, 12288
    buffer_load_dwordx4 v[68:71], v2, s[44:47], s17 offen offset:0 sc1
    buffer_load_dwordx4 v[72:75], v2, s[44:47], s17 offen offset:1024 sc1
    buffer_load_dwordx4 v[76:79], v2, s[44:47], s17 offen offset:2048 sc1
    buffer_load_dwordx4 v[80:83], v2, s[44:47], s17 offen offset:3072 sc1
K2T_WAIT3:
    ds_read_b64 v[136:137], v134 offset:12
    ds_read_b32 v135, v134 offset:20
    s_waitcnt lgkmcnt(0)
    v_readfirstlane_b32 s21, v136
    v_readfirstlane_b32 s22, v135
    s_cmp_ge_u32 s21, 8
    s_cbranch_scc0 K2T_WAIT3
    s_cmp_ge_u32 s22, 2
    s_cbranch_scc0 K2T_WAIT3
    ds_read_b64_tr_b16 v[84:85], v3 offset:0
    ds_read_b64_tr_b16 v[86:87], v3 offset:1024
    ds_read_b64_tr_b16 v[88:89], v3 offset:2048
    ds_read_b64_tr_b16 v[90:91], v3 offset:3072
    ds_read_b64_tr_b16 v[92:93], v3 offset:4096
    ds_read_b64_tr_b16 v[94:95], v3 offset:5120
    ds_read_b64_tr_b16 v[96:97], v3 offset:6144
    ds_read_b64_tr_b16 v[98:99], v3 offset:7168
    s_waitcnt vmcnt(12)
    s_waitcnt lgkmcnt(6)
    v_mfma_f32_32x32x16_bf16 v[100:115], v[84:87], v[20:23], v[100:115]
    s_waitcnt lgkmcnt(4)
    v_mfma_f32_32x32x16_bf16 v[100:115], v[88:91], v[24:27], v[100:115]
    s_waitcnt lgkmcnt(2)
    v_mfma_f32_32x32x16_bf16 v[100:115], v[92:95], v[28:31], v[100:115]
    s_waitcnt lgkmcnt(0)
    v_mfma_f32_32x32x16_bf16 v[100:115], v[96:99], v[32:35], v[100:115]
    ds_read_b64_tr_b16 v[84:85], v3 offset:8192
    ds_read_b64_tr_b16 v[86:87], v3 offset:9216
    ds_read_b64_tr_b16 v[88:89], v3 offset:10240
    ds_read_b64_tr_b16 v[90:91], v3 offset:11264
    ds_read_b64_tr_b16 v[92:93], v3 offset:12288
    ds_read_b64_tr_b16 v[94:95], v3 offset:13312
    ds_read_b64_tr_b16 v[96:97], v3 offset:14336
    ds_read_b64_tr_b16 v[98:99], v3 offset:15360
    s_waitcnt vmcnt(8)
    s_waitcnt lgkmcnt(6)
    v_mfma_f32_32x32x16_bf16 v[100:115], v[84:87], v[36:39], v[100:115]
    s_waitcnt lgkmcnt(4)
    v_mfma_f32_32x32x16_bf16 v[100:115], v[88:91], v[40:43], v[100:115]
    s_waitcnt lgkmcnt(2)
    v_mfma_f32_32x32x16_bf16 v[100:115], v[92:95], v[44:47], v[100:115]
    s_waitcnt lgkmcnt(0)
    v_mfma_f32_32x32x16_bf16 v[100:115], v[96:99], v[48:51], v[100:115]
    ds_read_b64_tr_b16 v[84:85], v3 offset:16384
    ds_read_b64_tr_b16 v[86:87], v3 offset:17408
    ds_read_b64_tr_b16 v[88:89], v3 offset:18432
    ds_read_b64_tr_b16 v[90:91], v3 offset:19456
    ds_read_b64_tr_b16 v[92:93], v3 offset:20480
    ds_read_b64_tr_b16 v[94:95], v3 offset:21504
    ds_read_b64_tr_b16 v[96:97], v3 offset:22528
    ds_read_b64_tr_b16 v[98:99], v3 offset:23552
    s_waitcnt vmcnt(4)
    s_waitcnt lgkmcnt(6)
    v_mfma_f32_32x32x16_bf16 v[100:115], v[84:87], v[52:55], v[100:115]
    s_waitcnt lgkmcnt(4)
    v_mfma_f32_32x32x16_bf16 v[100:115], v[88:91], v[56:59], v[100:115]
    s_waitcnt lgkmcnt(2)
    v_mfma_f32_32x32x16_bf16 v[100:115], v[92:95], v[60:63], v[100:115]
    s_waitcnt lgkmcnt(0)
    v_mfma_f32_32x32x16_bf16 v[100:115], v[96:99], v[64:67], v[100:115]
    ds_read_b64_tr_b16 v[84:85], v3 offset:24576
    ds_read_b64_tr_b16 v[86:87], v3 offset:25600
    ds_read_b64_tr_b16 v[88:89], v3 offset:26624
    ds_read_b64_tr_b16 v[90:91], v3 offset:27648
    ds_read_b64_tr_b16 v[92:93], v3 offset:28672
    ds_read_b64_tr_b16 v[94:95], v3 offset:29696
    ds_read_b64_tr_b16 v[96:97], v3 offset:30720
    ds_read_b64_tr_b16 v[98:99], v3 offset:31744
    s_waitcnt vmcnt(0)
    s_waitcnt lgkmcnt(6)
    v_mfma_f32_32x32x16_bf16 v[100:115], v[84:87], v[68:71], v[100:115]
    s_waitcnt lgkmcnt(4)
    v_mfma_f32_32x32x16_bf16 v[100:115], v[88:91], v[72:75], v[100:115]
    s_waitcnt lgkmcnt(2)
    v_mfma_f32_32x32x16_bf16 v[100:115], v[92:95], v[76:79], v[100:115]
    s_waitcnt lgkmcnt(0)
    v_mfma_f32_32x32x16_bf16 v[100:115], v[96:99], v[80:83], v[100:115]
    s_nop 7
    s_add_u32 s17, s16, 16384
    buffer_load_dwordx4 v[20:23], v2, s[44:47], s17 offen offset:0 sc1
    buffer_load_dwordx4 v[24:27], v2, s[44:47], s17 offen offset:1024 sc1
    buffer_load_dwordx4 v[28:31], v2, s[44:47], s17 offen offset:2048 sc1
    buffer_load_dwordx4 v[32:35], v2, s[44:47], s17 offen offset:3072 sc1
    s_add_u32 s17, s16, 20480
    buffer_load_dwordx4 v[36:39], v2, s[44:47], s17 offen offset:0 sc1
    buffer_load_dwordx4 v[40:43], v2, s[44:47], s17 offen offset:1024 sc1
    buffer_load_dwordx4 v[44:47], v2, s[44:47], s17 offen offset:2048 sc1
    buffer_load_dwordx4 v[48:51], v2, s[44:47], s17 offen offset:3072 sc1
    s_add_u32 s17, s16, 24576
    buffer_load_dwordx4 v[52:55], v2, s[44:47], s17 offen offset:0 sc1
    buffer_load_dwordx4 v[56:59], v2, s[44:47], s17 offen offset:1024 sc1
    buffer_load_dwordx4 v[60:63], v2, s[44:47], s17 offen offset:2048 sc1
    buffer_load_dwordx4 v[64:67], v2, s[44:47], s17 offen offset:3072 sc1
    s_add_u32 s17, s16, 28672
    buffer_load_dwordx4 v[68:71], v2, s[44:47], s17 offen offset:0 sc1
    buffer_load_dwordx4 v[72:75], v2, s[44:47], s17 offen offset:1024 sc1
    buffer_load_dwordx4 v[76:79], v2, s[44:47], s17 offen offset:2048 sc1
    buffer_load_dwordx4 v[80:83], v2, s[44:47], s17 offen offset:3072 sc1
    ds_read_b64_tr_b16 v[84:85], v3 offset:32768
    ds_read_b64_tr_b16 v[86:87], v3 offset:33792
    ds_read_b64_tr_b16 v[88:89], v3 offset:34816
    ds_read_b64_tr_b16 v[90:91], v3 offset:35840
    ds_read_b64_tr_b16 v[92:93], v3 offset:36864
    ds_read_b64_tr_b16 v[94:95], v3 offset:37888
    ds_read_b64_tr_b16 v[96:97], v3 offset:38912
    ds_read_b64_tr_b16 v[98:99], v3 offset:39936
    s_waitcnt vmcnt(12)
    s_waitcnt lgkmcnt(6)
    v_mfma_f32_32x32x16_bf16 v[100:115], v[84:87], v[20:23], v[100:115]
    s_waitcnt lgkmcnt(4)
    v_mfma_f32_32x32x16_bf16 v[100:115], v[88:91], v[24:27], v[100:115]
    s_waitcnt lgkmcnt(2)
    v_mfma_f32_32x32x16_bf16 v[100:115], v[92:95], v[28:31], v[100:115]
    s_waitcnt lgkmcnt(0)
    v_mfma_f32_32x32x16_bf16 v[100:115], v[96:99], v[32:35], v[100:115]
    ds_read_b64_tr_b16 v[84:85], v3 offset:40960
    ds_read_b64_tr_b16 v[86:87], v3 offset:41984
    ds_read_b64_tr_b16 v[88:89], v3 offset:43008
    ds_read_b64_tr_b16 v[90:91], v3 offset:44032
    ds_read_b64_tr_b16 v[92:93], v3 offset:45056
    ds_read_b64_tr_b16 v[94:95], v3 offset:46080
    ds_read_b64_tr_b16 v[96:97], v3 offset:47104
    ds_read_b64_tr_b16 v[98:99], v3 offset:48128
    s_waitcnt vmcnt(8)
    s_waitcnt lgkmcnt(6)
    v_mfma_f32_32x32x16_bf16 v[100:115], v[84:87], v[36:39], v[100:115]
    s_waitcnt lgkmcnt(4)
    v_mfma_f32_32x32x16_bf16 v[100:115], v[88:91], v[40:43], v[100:115]
    s_waitcnt lgkmcnt(2)
    v_mfma_f32_32x32x16_bf16 v[100:115], v[92:95], v[44:47], v[100:115]
    s_waitcnt lgkmcnt(0)
    v_mfma_f32_32x32x16_bf16 v[100:115], v[96:99], v[48:51], v[100:115]
    ds_read_b64_tr_b16 v[84:85], v3 offset:49152
    ds_read_b64_tr_b16 v[86:87], v3 offset:50176
    ds_read_b64_tr_b16 v[88:89], v3 offset:51200
    ds_read_b64_tr_b16 v[90:91], v3 offset:52224
    ds_read_b64_tr_b16 v[92:93], v3 offset:53248
    ds_read_b64_tr_b16 v[94:95], v3 offset:54272
    ds_read_b64_tr_b16 v[96:97], v3 offset:55296
    ds_read_b64_tr_b16 v[98:99], v3 offset:56320
    s_waitcnt vmcnt(4)
    s_waitcnt lgkmcnt(6)
    v_mfma_f32_32x32x16_bf16 v[100:115], v[84:87], v[52:55], v[100:115]
    s_waitcnt lgkmcnt(4)
    v_mfma_f32_32x32x16_bf16 v[100:115], v[88:91], v[56:59], v[100:115]
    s_waitcnt lgkmcnt(2)
    v_mfma_f32_32x32x16_bf16 v[100:115], v[92:95], v[60:63], v[100:115]
    s_waitcnt lgkmcnt(0)
    v_mfma_f32_32x32x16_bf16 v[100:115], v[96:99], v[64:67], v[100:115]
    ds_read_b64_tr_b16 v[84:85], v3 offset:57344
    ds_read_b64_tr_b16 v[86:87], v3 offset:58368
    ds_read_b64_tr_b16 v[88:89], v3 offset:59392
    ds_read_b64_tr_b16 v[90:91], v3 offset:60416
    ds_read_b64_tr_b16 v[92:93], v3 offset:61440
    ds_read_b64_tr_b16 v[94:95], v3 offset:62464
    ds_read_b64_tr_b16 v[96:97], v3 offset:63488
    ds_read_b64_tr_b16 v[98:99], v3 offset:64512
    s_waitcnt vmcnt(0)
    s_waitcnt lgkmcnt(6)
    v_mfma_f32_32x32x16_bf16 v[100:115], v[84:87], v[68:71], v[100:115]
    s_waitcnt lgkmcnt(4)
    v_mfma_f32_32x32x16_bf16 v[100:115], v[88:91], v[72:75], v[100:115]
    s_waitcnt lgkmcnt(2)
    v_mfma_f32_32x32x16_bf16 v[100:115], v[92:95], v[76:79], v[100:115]
    s_waitcnt lgkmcnt(0)
    v_mfma_f32_32x32x16_bf16 v[100:115], v[96:99], v[80:83], v[100:115]
    s_lshl_b32 s14, s62, 14
    s_lshl_b32 s15, s61, 11
    s_add_u32 s14, s14, s15
    s_add_u32 s14, s14, 0x20000
    v_lshlrev_b32 v5, 5, v1
    v_add_u32 v5, s14, v5
    ds_read_b128 v[136:139], v5
    ds_read_b128 v[140:143], v5 offset:16
    v_lshlrev_b32 v8, 10, v7
    v_lshrrev_b32 v10, 5, v1
    v_lshl_add_u32 v8, v10, 5, v8
    s_lshl_b32 s14, s27, 7
    s_lshl_b32 s15, s62, 6
    s_add_u32 s14, s14, s15
    v_sub_f32 v10, 1.0, v12
    v_cvt_pk_bf16_f32 v11, v10, v10
    v_lshlrev_b32 v10, 16, v11
    s_waitcnt lgkmcnt(0)
    s_nop 7
    v_lshlrev_b32 v36, 16, v136
    v_and_b32 v37, 0xffff0000, v136
    v_cvt_pk_bf16_f32 v128, v100, v101
    v_lshlrev_b32 v100, 16, v128
    v_and_b32 v101, 0xffff0000, v128
    v_mul_f32 v100, v100, v12
    v_mul_f32 v101, v101, v12
    v_mul_f32 v36, v36, v10
    v_mul_f32 v37, v37, v10
    v_cvt_pk_bf16_f32 v128, v100, v101
    v_lshlrev_b32 v100, 16, v128
    v_and_b32 v101, 0xffff0000, v128
    v_cvt_pk_bf16_f32 v129, v36, v37
    v_lshlrev_b32 v36, 16, v129
    v_and_b32 v37, 0xffff0000, v129
    v_add_f32 v100, v100, v36
    v_add_f32 v101, v101, v37
    v_cvt_pk_bf16_f32 v120, v100, v101
    v_lshlrev_b32 v38, 16, v137
    v_and_b32 v39, 0xffff0000, v137
    v_cvt_pk_bf16_f32 v128, v102, v103
    v_lshlrev_b32 v102, 16, v128
    v_and_b32 v103, 0xffff0000, v128
    v_mul_f32 v102, v102, v12
    v_mul_f32 v103, v103, v12
    v_mul_f32 v38, v38, v10
    v_mul_f32 v39, v39, v10
    v_cvt_pk_bf16_f32 v128, v102, v103
    v_lshlrev_b32 v102, 16, v128
    v_and_b32 v103, 0xffff0000, v128
    v_cvt_pk_bf16_f32 v129, v38, v39
    v_lshlrev_b32 v38, 16, v129
    v_and_b32 v39, 0xffff0000, v129
    v_add_f32 v102, v102, v38
    v_add_f32 v103, v103, v39
    v_cvt_pk_bf16_f32 v121, v102, v103
    v_lshlrev_b32 v40, 16, v138
    v_and_b32 v41, 0xffff0000, v138
    v_cvt_pk_bf16_f32 v128, v104, v105
    v_lshlrev_b32 v104, 16, v128
    v_and_b32 v105, 0xffff0000, v128
    v_mul_f32 v104, v104, v12
    v_mul_f32 v105, v105, v12
    v_mul_f32 v40, v40, v10
    v_mul_f32 v41, v41, v10
    v_cvt_pk_bf16_f32 v128, v104, v105
    v_lshlrev_b32 v104, 16, v128
    v_and_b32 v105, 0xffff0000, v128
    v_cvt_pk_bf16_f32 v129, v40, v41
    v_lshlrev_b32 v40, 16, v129
    v_and_b32 v41, 0xffff0000, v129
    v_add_f32 v104, v104, v40
    v_add_f32 v105, v105, v41
    v_cvt_pk_bf16_f32 v122, v104, v105
    v_lshlrev_b32 v42, 16, v139
    v_and_b32 v43, 0xffff0000, v139
    v_cvt_pk_bf16_f32 v128, v106, v107
    v_lshlrev_b32 v106, 16, v128
    v_and_b32 v107, 0xffff0000, v128
    v_mul_f32 v106, v106, v12
    v_mul_f32 v107, v107, v12
    v_mul_f32 v42, v42, v10
    v_mul_f32 v43, v43, v10
    v_cvt_pk_bf16_f32 v128, v106, v107
    v_lshlrev_b32 v106, 16, v128
    v_and_b32 v107, 0xffff0000, v128
    v_cvt_pk_bf16_f32 v129, v42, v43
    v_lshlrev_b32 v42, 16, v129
    v_and_b32 v43, 0xffff0000, v129
    v_add_f32 v106, v106, v42
    v_add_f32 v107, v107, v43
    v_cvt_pk_bf16_f32 v123, v106, v107
    v_lshlrev_b32 v44, 16, v140
    v_and_b32 v45, 0xffff0000, v140
    v_cvt_pk_bf16_f32 v128, v108, v109
    v_lshlrev_b32 v108, 16, v128
    v_and_b32 v109, 0xffff0000, v128
    v_mul_f32 v108, v108, v12
    v_mul_f32 v109, v109, v12
    v_mul_f32 v44, v44, v10
    v_mul_f32 v45, v45, v10
    v_cvt_pk_bf16_f32 v128, v108, v109
    v_lshlrev_b32 v108, 16, v128
    v_and_b32 v109, 0xffff0000, v128
    v_cvt_pk_bf16_f32 v129, v44, v45
    v_lshlrev_b32 v44, 16, v129
    v_and_b32 v45, 0xffff0000, v129
    v_add_f32 v108, v108, v44
    v_add_f32 v109, v109, v45
    v_cvt_pk_bf16_f32 v124, v108, v109
    v_lshlrev_b32 v46, 16, v141
    v_and_b32 v47, 0xffff0000, v141
    v_cvt_pk_bf16_f32 v128, v110, v111
    v_lshlrev_b32 v110, 16, v128
    v_and_b32 v111, 0xffff0000, v128
    v_mul_f32 v110, v110, v12
    v_mul_f32 v111, v111, v12
    v_mul_f32 v46, v46, v10
    v_mul_f32 v47, v47, v10
    v_cvt_pk_bf16_f32 v128, v110, v111
    v_lshlrev_b32 v110, 16, v128
    v_and_b32 v111, 0xffff0000, v128
    v_cvt_pk_bf16_f32 v129, v46, v47
    v_lshlrev_b32 v46, 16, v129
    v_and_b32 v47, 0xffff0000, v129
    v_add_f32 v110, v110, v46
    v_add_f32 v111, v111, v47
    v_cvt_pk_bf16_f32 v125, v110, v111
    v_lshlrev_b32 v48, 16, v142
    v_and_b32 v49, 0xffff0000, v142
    v_cvt_pk_bf16_f32 v128, v112, v113
    v_lshlrev_b32 v112, 16, v128
    v_and_b32 v113, 0xffff0000, v128
    v_mul_f32 v112, v112, v12
    v_mul_f32 v113, v113, v12
    v_mul_f32 v48, v48, v10
    v_mul_f32 v49, v49, v10
    v_cvt_pk_bf16_f32 v128, v112, v113
    v_lshlrev_b32 v112, 16, v128
    v_and_b32 v113, 0xffff0000, v128
    v_cvt_pk_bf16_f32 v129, v48, v49
    v_lshlrev_b32 v48, 16, v129
    v_and_b32 v49, 0xffff0000, v129
    v_add_f32 v112, v112, v48
    v_add_f32 v113, v113, v49
    v_cvt_pk_bf16_f32 v126, v112, v113
    v_lshlrev_b32 v50, 16, v143
    v_and_b32 v51, 0xffff0000, v143
    v_cvt_pk_bf16_f32 v128, v114, v115
    v_lshlrev_b32 v114, 16, v128
    v_and_b32 v115, 0xffff0000, v128
    v_mul_f32 v114, v114, v12
    v_mul_f32 v115, v115, v12
    v_mul_f32 v50, v50, v10
    v_mul_f32 v51, v51, v10
    v_cvt_pk_bf16_f32 v128, v114, v115
    v_lshlrev_b32 v114, 16, v128
    v_and_b32 v115, 0xffff0000, v128
    v_cvt_pk_bf16_f32 v129, v50, v51
    v_lshlrev_b32 v50, 16, v129
    v_and_b32 v51, 0xffff0000, v129
    v_add_f32 v114, v114, v50
    v_add_f32 v115, v115, v51
    v_cvt_pk_bf16_f32 v127, v114, v115
    buffer_store_dwordx4 v[120:123], v8, s[56:59], s14 offen sc1
    buffer_store_dwordx4 v[124:127], v8, s[56:59], s14 offen offset:16 sc1
    s_branch K2_END
K2_FFN:
    s_mov_b32 s40, s28
    s_and_b32 s41, s29, 0xffff
    s_mov_b32 s42, 1409024
    s_mov_b32 s43, 0x20000
    s_sub_u32 s3, s3, 8
    s_mov_b32 s4, s26
    s_mov_b32 s5, s27
    s_lshl_b32 s8, s4, 1
    s_mul_i32 s10, s8, 86
    s_lshl_b32 s10, s10, 10
    s_add_u32 s10, s10, 10485760
    s_add_u32 s11, s10, 88064
    s_mov_b32 s14, 0
    s_lshl_b32 s15, s3, 14
    s_add_u32 s15, s15, 0x20000
    v_lshrrev_b32 v4, 2, v1
    v_lshlrev_b32 v4, 10, v4
    v_and_b32 v6, 3, v1
    v_lshl_add_u32 v4, v6, 4, v4
    s_lshl_b32 s9, s5, 7
    s_lshl_b32 s12, s3, 6
    s_add_u32 s9, s9, s12
    v_add_u32 v8, s9, v4
    v_bfe_u32 v5, v1, 2, 2
    v_lshrrev_b32 v6, 5, v1
    v_lshl_add_u32 v6, v6, 2, v5
    v_lshlrev_b32 v6, 6, v6
    v_add_u32 v6, s15, v6
    v_bfe_u32 v7, v1, 0, 1
    v_lshl_add_u32 v6, v7, 5, v6
    v_bfe_u32 v7, v1, 4, 1
    v_lshl_add_u32 v6, v7, 4, v6
    v_bfe_u32 v7, v1, 1, 1
    v_lshl_add_u32 v3, v7, 3, v6
    v_mov_b32 v120, 0
    v_mov_b32 v121, 0
    v_mov_b32 v122, 0
    v_mov_b32 v123, 0
    v_mov_b32 v124, 0
    v_mov_b32 v125, 0
    v_mov_b32 v126, 0
    v_mov_b32 v127, 0
    v_mov_b32 v128, 0
    v_mov_b32 v129, 0
    v_mov_b32 v130, 0
    v_mov_b32 v131, 0
    v_mov_b32 v132, 0
    v_mov_b32 v133, 0
    v_mov_b32 v134, 0
    v_mov_b32 v135, 0
    v_mov_b32 v136, 0
    v_mov_b32 v137, 0
    v_mov_b32 v138, 0
    v_mov_b32 v139, 0
    v_mov_b32 v140, 0
    v_mov_b32 v141, 0
    v_mov_b32 v142, 0
    v_mov_b32 v143, 0
    v_mov_b32 v144, 0
    v_mov_b32 v145, 0
    v_mov_b32 v146, 0
    v_mov_b32 v147, 0
    v_mov_b32 v148, 0
    v_mov_b32 v149, 0
    v_mov_b32 v150, 0
    v_mov_b32 v151, 0
    s_add_u32 m0, s15, 0
    s_add_u32 s52, s14, 0
    buffer_load_dwordx4 v8, s[40:43], s52 offen lds
    s_add_u32 m0, s15, 1024
    s_add_u32 s52, s14, 16384
    buffer_load_dwordx4 v8, s[40:43], s52 offen lds
    buffer_load_dwordx4 v[16:19], v2, s[44:47], s10 offen offset:0
    buffer_load_dwordx4 v[24:27], v2, s[44:47], s10 offen offset:1024
    buffer_load_dwordx4 v[20:23], v2, s[44:47], s11 offen offset:0
    buffer_load_dwordx4 v[28:31], v2, s[44:47], s11 offen offset:1024
    s_add_u32 s14, s14, 32768
    s_add_u32 s10, s10, 2048
    s_add_u32 s11, s11, 2048
    s_add_u32 m0, s15, 2048
    s_add_u32 s52, s14, 0
    buffer_load_dwordx4 v8, s[40:43], s52 offen lds
    s_add_u32 m0, s15, 3072
    s_add_u32 s52, s14, 16384
    buffer_load_dwordx4 v8, s[40:43], s52 offen lds
    buffer_load_dwordx4 v[32:35], v2, s[44:47], s10 offen offset:0
    buffer_load_dwordx4 v[40:43], v2, s[44:47], s10 offen offset:1024
    buffer_load_dwordx4 v[36:39], v2, s[44:47], s11 offen offset:0
    buffer_load_dwordx4 v[44:47], v2, s[44:47], s11 offen offset:1024
    s_add_u32 s14, s14, 32768
    s_add_u32 s10, s10, 2048
    s_add_u32 s11, s11, 2048
    s_add_u32 m0, s15, 4096
    s_add_u32 s52, s14, 0
    buffer_load_dwordx4 v8, s[40:43], s52 offen lds
    s_add_u32 m0, s15, 5120
    s_add_u32 s52, s14, 16384
    buffer_load_dwordx4 v8, s[40:43], s52 offen lds
    buffer_load_dwordx4 v[48:51], v2, s[44:47], s10 offen offset:0
    buffer_load_dwordx4 v[56:59], v2, s[44:47], s10 offen offset:1024
    buffer_load_dwordx4 v[52:55], v2, s[44:47], s11 offen offset:0
    buffer_load_dwordx4 v[60:63], v2, s[44:47], s11 offen offset:1024
    s_add_u32 s14, s14, 32768
    s_add_u32 s10, s10, 2048
    s_add_u32 s11, s11, 2048
    s_add_u32 m0, s15, 6144
    s_add_u32 s52, s14, 0
    buffer_load_dwordx4 v8, s[40:43], s52 offen lds
    s_add_u32 m0, s15, 7168
    s_add_u32 s52, s14, 16384
    buffer_load_dwordx4 v8, s[40:43], s52 offen lds
    buffer_load_dwordx4 v[64:67], v2, s[44:47], s10 offen offset:0
    buffer_load_dwordx4 v[72:75], v2, s[44:47], s10 offen offset:1024
    buffer_load_dwordx4 v[68:71], v2, s[44:47], s11 offen offset:0
    buffer_load_dwordx4 v[76:79], v2, s[44:47], s11 offen offset:1024
    s_add_u32 s14, s14, 32768
    s_add_u32 s10, s10, 2048
    s_add_u32 s11, s11, 2048
    s_add_u32 m0, s15, 8192
    s_add_u32 s52, s14, 0
    buffer_load_dwordx4 v8, s[40:43], s52 offen lds
    s_add_u32 m0, s15, 9216
    s_add_u32 s52, s14, 16384
    buffer_load_dwordx4 v8, s[40:43], s52 offen lds
    buffer_load_dwordx4 v[80:83], v2, s[44:47], s10 offen offset:0
    buffer_load_dwordx4 v[88:91], v2, s[44:47], s10 offen offset:1024
    buffer_load_dwordx4 v[84:87], v2, s[44:47], s11 offen offset:0
    buffer_load_dwordx4 v[92:95], v2, s[44:47], s11 offen offset:1024
    s_add_u32 s14, s14, 32768
    s_add_u32 s10, s10, 2048
    s_add_u32 s11, s11, 2048
    s_mov_b32 s53, 0
K2F_LOOP:
    s_add_u32 m0, s15, 10240
    s_add_u32 s52, s14, 0
    buffer_load_dwordx4 v8, s[40:43], s52 offen lds
    s_add_u32 m0, s15, 11264
    s_add_u32 s52, s14, 16384
    buffer_load_dwordx4 v8, s[40:43], s52 offen lds
    buffer_load_dwordx4 v[96:99], v2, s[44:47], s10 offen offset:0
    buffer_load_dwordx4 v[104:107], v2, s[44:47], s10 offen offset:1024
    buffer_load_dwordx4 v[100:103], v2, s[44:47], s11 offen offset:0
    buffer_load_dwordx4 v[108:111], v2, s[44:47], s11 offen offset:1024
    s_add_u32 s14, s14, 32768
    s_add_u32 s10, s10, 2048
    s_add_u32 s11, s11, 2048
    s_waitcnt vmcnt(30)
    ds_read_b64_tr_b16 v[112:113], v3 offset:0
    ds_read_b64_tr_b16 v[114:115], v3 offset:512
    ds_read_b64_tr_b16 v[116:117], v3 offset:1024
    ds_read_b64_tr_b16 v[118:119], v3 offset:1536
    s_waitcnt lgkmcnt(2)
    v_mfma_f32_32x32x16_bf16 v[120:135], v[112:115], v[16:19], v[120:135]
    v_mfma_f32_32x32x16_bf16 v[136:151], v[112:115], v[20:23], v[136:151]
    s_waitcnt lgkmcnt(0)
    v_mfma_f32_32x32x16_bf16 v[120:135], v[116:119], v[24:27], v[120:135]
    v_mfma_f32_32x32x16_bf16 v[136:151], v[116:119], v[28:31], v[136:151]
    s_add_u32 s53, s53, 1
    s_cmp_ge_u32 s53, 43
    s_cbranch_scc1 K2F_DONE
    s_add_u32 m0, s15, 0
    s_add_u32 s52, s14, 0
    buffer_load_dwordx4 v8, s[40:43], s52 offen lds
    s_add_u32 m0, s15, 1024
    s_add_u32 s52, s14, 16384
    buffer_load_dwordx4 v8, s[40:43], s52 offen lds
    buffer_load_dwordx4 v[16:19], v2, s[44:47], s10 offen offset:0
    buffer_load_dwordx4 v[24:27], v2, s[44:47], s10 offen offset:1024
    buffer_load_dwordx4 v[20:23], v2, s[44:47], s11 offen offset:0
    buffer_load_dwordx4 v[28:31], v2, s[44:47], s11 offen offset:1024
    s_add_u32 s14, s14, 32768
    s_add_u32 s10, s10, 2048
    s_add_u32 s11, s11, 2048
    s_waitcnt vmcnt(30)
    ds_read_b64_tr_b16 v[112:113], v3 offset:2048
    ds_read_b64_tr_b16 v[114:115], v3 offset:2560
    ds_read_b64_tr_b16 v[116:117], v3 offset:3072
    ds_read_b64_tr_b16 v[118:119], v3 offset:3584
    s_waitcnt lgkmcnt(2)
    v_mfma_f32_32x32x16_bf16 v[120:135], v[112:115], v[32:35], v[120:135]
    v_mfma_f32_32x32x16_bf16 v[136:151], v[112:115], v[36:39], v[136:151]
    s_waitcnt lgkmcnt(0)
    v_mfma_f32_32x32x16_bf16 v[120:135], v[116:119], v[40:43], v[120:135]
    v_mfma_f32_32x32x16_bf16 v[136:151], v[116:119], v[44:47], v[136:151]
    s_add_u32 s53, s53, 1
    s_cmp_ge_u32 s53, 43
    s_cbranch_scc1 K2F_DONE
    s_add_u32 m0, s15, 2048
    s_add_u32 s52, s14, 0
    buffer_load_dwordx4 v8, s[40:43], s52 offen lds
    s_add_u32 m0, s15, 3072
    s_add_u32 s52, s14, 16384
    buffer_load_dwordx4 v8, s[40:43], s52 offen lds
    buffer_load_dwordx4 v[32:35], v2, s[44:47], s10 offen offset:0
    buffer_load_dwordx4 v[40:43], v2, s[44:47], s10 offen offset:1024
    buffer_load_dwordx4 v[36:39], v2, s[44:47], s11 offen offset:0
    buffer_load_dwordx4 v[44:47], v2, s[44:47], s11 offen offset:1024
    s_add_u32 s14, s14, 32768
    s_add_u32 s10, s10, 2048
    s_add_u32 s11, s11, 2048
    s_waitcnt vmcnt(30)
    ds_read_b64_tr_b16 v[112:113], v3 offset:4096
    ds_read_b64_tr_b16 v[114:115], v3 offset:4608
    ds_read_b64_tr_b16 v[116:117], v3 offset:5120
    ds_read_b64_tr_b16 v[118:119], v3 offset:5632
    s_waitcnt lgkmcnt(2)
    v_mfma_f32_32x32x16_bf16 v[120:135], v[112:115], v[48:51], v[120:135]
    v_mfma_f32_32x32x16_bf16 v[136:151], v[112:115], v[52:55], v[136:151]
    s_waitcnt lgkmcnt(0)
    v_mfma_f32_32x32x16_bf16 v[120:135], v[116:119], v[56:59], v[120:135]
    v_mfma_f32_32x32x16_bf16 v[136:151], v[116:119], v[60:63], v[136:151]
    s_add_u32 s53, s53, 1
    s_cmp_ge_u32 s53, 43
    s_cbranch_scc1 K2F_DONE
    s_add_u32 m0, s15, 4096
    s_add_u32 s52, s14, 0
    buffer_load_dwordx4 v8, s[40:43], s52 offen lds
    s_add_u32 m0, s15, 5120
    s_add_u32 s52, s14, 16384
    buffer_load_dwordx4 v8, s[40:43], s52 offen lds
    buffer_load_dwordx4 v[48:51], v2, s[44:47], s10 offen offset:0
    buffer_load_dwordx4 v[56:59], v2, s[44:47], s10 offen offset:1024
    buffer_load_dwordx4 v[52:55], v2, s[44:47], s11 offen offset:0
    buffer_load_dwordx4 v[60:63], v2, s[44:47], s11 offen offset:1024
    s_add_u32 s14, s14, 32768
    s_add_u32 s10, s10, 2048
    s_add_u32 s11, s11, 2048
    s_waitcnt vmcnt(30)
    ds_read_b64_tr_b16 v[112:113], v3 offset:6144
    ds_read_b64_tr_b16 v[114:115], v3 offset:6656
    ds_read_b64_tr_b16 v[116:117], v3 offset:7168
    ds_read_b64_tr_b16 v[118:119], v3 offset:7680
    s_waitcnt lgkmcnt(2)
    v_mfma_f32_32x32x16_bf16 v[120:135], v[112:115], v[64:67], v[120:135]
    v_mfma_f32_32x32x16_bf16 v[136:151], v[112:115], v[68:71], v[136:151]
    s_waitcnt lgkmcnt(0)
    v_mfma_f32_32x32x16_bf16 v[120:135], v[116:119], v[72:75], v[120:135]
    v_mfma_f32_32x32x16_bf16 v[136:151], v[116:119], v[76:79], v[136:151]
    s_add_u32 s53, s53, 1
    s_cmp_ge_u32 s53, 43
    s_cbranch_scc1 K2F_DONE
    s_add_u32 m0, s15, 6144
    s_add_u32 s52, s14, 0
    buffer_load_dwordx4 v8, s[40:43], s52 offen lds
    s_add_u32 m0, s15, 7168
    s_add_u32 s52, s14, 16384
    buffer_load_dwordx4 v8, s[40:43], s52 offen lds
    buffer_load_dwordx4 v[64:67], v2, s[44:47], s10 offen offset:0
    buffer_load_dwordx4 v[72:75], v2, s[44:47], s10 offen offset:1024
    buffer_load_dwordx4 v[68:71], v2, s[44:47], s11 offen offset:0
    buffer_load_dwordx4 v[76:79], v2, s[44:47], s11 offen offset:1024
    s_add_u32 s14, s14, 32768
    s_add_u32 s10, s10, 2048
    s_add_u32 s11, s11, 2048
    s_waitcnt vmcnt(30)
    ds_read_b64_tr_b16 v[112:113], v3 offset:8192
    ds_read_b64_tr_b16 v[114:115], v3 offset:8704
    ds_read_b64_tr_b16 v[116:117], v3 offset:9216
    ds_read_b64_tr_b16 v[118:119], v3 offset:9728
    s_waitcnt lgkmcnt(2)
    v_mfma_f32_32x32x16_bf16 v[120:135], v[112:115], v[80:83], v[120:135]
    v_mfma_f32_32x32x16_bf16 v[136:151], v[112:115], v[84:87], v[136:151]
    s_waitcnt lgkmcnt(0)
    v_mfma_f32_32x32x16_bf16 v[120:135], v[116:119], v[88:91], v[120:135]
    v_mfma_f32_32x32x16_bf16 v[136:151], v[116:119], v[92:95], v[136:151]
    s_add_u32 s53, s53, 1
    s_cmp_ge_u32 s53, 43
    s_cbranch_scc1 K2F_DONE
    s_add_u32 m0, s15, 8192
    s_add_u32 s52, s14, 0
    buffer_load_dwordx4 v8, s[40:43], s52 offen lds
    s_add_u32 m0, s15, 9216
    s_add_u32 s52, s14, 16384
    buffer_load_dwordx4 v8, s[40:43], s52 offen lds
    buffer_load_dwordx4 v[80:83], v2, s[44:47], s10 offen offset:0
    buffer_load_dwordx4 v[88:91], v2, s[44:47], s10 offen offset:1024
    buffer_load_dwordx4 v[84:87], v2, s[44:47], s11 offen offset:0
    buffer_load_dwordx4 v[92:95], v2, s[44:47], s11 offen offset:1024
    s_add_u32 s14, s14, 32768
    s_add_u32 s10, s10, 2048
    s_add_u32 s11, s11, 2048
    s_waitcnt vmcnt(30)
    ds_read_b64_tr_b16 v[112:113], v3 offset:10240
    ds_read_b64_tr_b16 v[114:115], v3 offset:10752
    ds_read_b64_tr_b16 v[116:117], v3 offset:11264
    ds_read_b64_tr_b16 v[118:119], v3 offset:11776
    s_waitcnt lgkmcnt(2)
    v_mfma_f32_32x32x16_bf16 v[120:135], v[112:115], v[96:99], v[120:135]
    v_mfma_f32_32x32x16_bf16 v[136:151], v[112:115], v[100:103], v[136:151]
    s_waitcnt lgkmcnt(0)
    v_mfma_f32_32x32x16_bf16 v[120:135], v[116:119], v[104:107], v[120:135]
    v_mfma_f32_32x32x16_bf16 v[136:151], v[116:119], v[108:111], v[136:151]
    s_add_u32 s53, s53, 1
    s_cmp_ge_u32 s53, 43
    s_cbranch_scc1 K2F_DONE
    s_branch K2F_LOOP
K2F_DONE:
    s_waitcnt vmcnt(0)
    v_lshlrev_b32 v4, 5, v1
    v_add_u32 v4, s15, v4
    s_nop 15
    s_nop 3
    v_cvt_pk_bf16_f32 v16, v120, v121
    v_cvt_pk_bf16_f32 v17, v122, v123
    v_cvt_pk_bf16_f32 v18, v124, v125
    v_cvt_pk_bf16_f32 v19, v126, v127
    v_cvt_pk_bf16_f32 v20, v128, v129
    v_cvt_pk_bf16_f32 v21, v130, v131
    v_cvt_pk_bf16_f32 v22, v132, v133
    v_cvt_pk_bf16_f32 v23, v134, v135
    ds_write_b128 v4, v[16:19] offset:0
    ds_write_b128 v4, v[20:23] offset:16
    v_cvt_pk_bf16_f32 v24, v136, v137
    v_cvt_pk_bf16_f32 v25, v138, v139
    v_cvt_pk_bf16_f32 v26, v140, v141
    v_cvt_pk_bf16_f32 v27, v142, v143
    v_cvt_pk_bf16_f32 v28, v144, v145
    v_cvt_pk_bf16_f32 v29, v146, v147
    v_cvt_pk_bf16_f32 v30, v148, v149
    v_cvt_pk_bf16_f32 v31, v150, v151
    ds_write_b128 v4, v[24:27] offset:2048
    ds_write_b128 v4, v[28:31] offset:2064
    s_waitcnt lgkmcnt(0)
    v_mov_b32 v5, 0x23000
    v_mov_b32 v6, 1
    s_mov_b64 exec, 1
    ds_add_u32 v5, v6 offset:20
    s_mov_b64 exec, -1
    s_waitcnt lgkmcnt(0)
K2_END:
    s_endpgm
.section .rodata,"a"
.p2align 6
.amdhsa_kernel k1_kernel
  .amdhsa_next_free_vgpr 192
  .amdhsa_next_free_sgpr 102
  .amdhsa_accum_offset 192
  .amdhsa_group_segment_fixed_size 0
  .amdhsa_kernarg_size 88
  .amdhsa_user_sgpr_count 2
  .amdhsa_user_sgpr_kernarg_segment_ptr 1
  .amdhsa_system_sgpr_workgroup_id_x 1
.end_amdhsa_kernel
.p2align 6
.amdhsa_kernel k2_kernel
  .amdhsa_next_free_vgpr 168
  .amdhsa_next_free_sgpr 102
  .amdhsa_accum_offset 168
  .amdhsa_group_segment_fixed_size 0
  .amdhsa_kernarg_size 88
  .amdhsa_user_sgpr_count 2
  .amdhsa_user_sgpr_kernarg_segment_ptr 1
  .amdhsa_system_sgpr_workgroup_id_x 1
.end_amdhsa_kernel
```
